```python
import torch

def _softmax(x, axis=-1):
    return torch.softmax(x, dim=axis)
def _gelu(x):
    return torch.nn.functional.gelu(x, approximate="tanh")
def _silu(x):
    return torch.nn.functional.silu(x)
def _sigmoid(x):
    return torch.sigmoid(x)
def _layernorm(x, axis=-1, eps=1e-5):
    m = x.mean(dim=axis, keepdim=True)
    v = x.var(dim=axis, keepdim=True, unbiased=False)
    return (x - m) / torch.sqrt(v + eps)
def _scatter_add(tgt, idx, src, axis=0):
    return tgt.clone().index_add_(axis, idx, src)
def _segment_sum(src, seg, n):
    out = torch.zeros((n,) + src.shape[1:], dtype=src.dtype)
    return out.index_add_(0, seg, src)
def _pad(x, pw):
    flat = tuple(v for pair in reversed(pw) for v in pair)
    return torch.nn.functional.pad(x, flat)

kernel_name = 'recurrent_scan__spectral_gfnet__mixer_channel_mlp__prompt'

def setup_inputs():

    _w = (lambda a: (lambda t: t.to(torch.bfloat16) if t.is_floating_point() else t)(torch.as_tensor(a)))
    def _A_setup():
        B, S, D = 1, 2048, 512
        Df = D // 2 + 1
        return {
            "x": _w((lambda *s: torch.randn(*s, dtype=torch.bfloat16) * 0.05)(B, S, D)),
            "w_r": _w((lambda *s: torch.randn(*s, dtype=torch.bfloat16) * 0.8)(S, Df) * 0.02),
            "w_i": _w((lambda *s: torch.randn(*s, dtype=torch.bfloat16) * 0.8)(S, Df) * 0.02),
        }
    _A_in = _A_setup()

    def _B_setup():
        B, S, D, F = 1, 2048, 512, 1792
        return {
            "x": _w((lambda *s: torch.randn(*s, dtype=torch.bfloat16) * 0.05)(B, S, D)),
            "w1": _w((lambda *s: torch.randn(*s, dtype=torch.bfloat16) * 0.8)(D, F) * (D ** -0.5)),
            "b1": _w((lambda *s: torch.randn(*s, dtype=torch.bfloat16) * 0.8)(F)),
            "w2": _w((lambda *s: torch.randn(*s, dtype=torch.bfloat16) * 0.8)(F, D) * (F ** -0.5)),
            "b2": _w((lambda *s: torch.randn(*s, dtype=torch.bfloat16) * 0.2)(D)),
        }
    _B_in = _B_setup()

    return {
        "A_x": _A_in["x"],
        "A_w_r": _A_in["w_r"],
        "A_w_i": _A_in["w_i"],
        "B_x": _B_in["x"],
        "B_w1": _B_in["w1"],
        "B_b1": _B_in["b1"],
        "B_w2": _B_in["w2"],
        "B_b2": _B_in["b2"],
    }

def reference(A_x, A_w_r, A_w_i, B_x, B_w1, B_b1, B_w2, B_b2):
    def _A_ref(x, w_r, w_i):
        B, S, D = x.shape
        X = (lambda x, axes=(-2,-1): torch.fft.rfft2(x.float(), dim=axes))(x, axes=(-2, -1))
        W = w_r + 1j * w_i
        X = X * W
        y = (lambda x, s, axes=(-2,-1): torch.fft.irfft2(x, s=s, dim=axes).to(torch.bfloat16))(X, (S, D), axes=(-2, -1))
        return y

    def _B_ref(x, w1, b1, w2, b2):
        y = _layernorm(x, axis=-1)
        h = _gelu(torch.einsum("bsd,df->bsf", y, w1) + b1)
        return torch.einsum("bsf,fd->bsd", h, w2) + b2

    x = A_x
    xn = _layernorm(x, axis=-1)
    s = _A_ref(xn, A_w_r, A_w_i)
    g = _silu(_B_ref(xn, B_w1, B_b1, B_w2, B_b2))
    return x + s * g
```

```asm
; @launch grid=(256,1,1) block=(512,1,1) lds=163840
.amdgcn_target "amdgcn-amd-amdhsa--gfx950"
.text
.set CODE_SPAN, CODE_END - recurrent_scan__spectral_gfnet__mixer_channel_mlp__prompt_kernel - 256
.globl recurrent_scan__spectral_gfnet__mixer_channel_mlp__prompt_kernel
.p2align 8
.type recurrent_scan__spectral_gfnet__mixer_channel_mlp__prompt_kernel,@function
recurrent_scan__spectral_gfnet__mixer_channel_mlp__prompt_kernel:
    s_cmp_ge_u32 s2, 256
    s_cbranch_scc1 END
    s_load_dwordx2 s[4:5], s[0:1], 0
    s_load_dwordx2 s[16:17], s[0:1], 32
    s_load_dwordx2 s[36:37], s[0:1], 80
    s_load_dwordx2 s[8:9], s[0:1], 8
    s_load_dwordx2 s[12:13], s[0:1], 16
    s_load_dwordx2 s[20:21], s[0:1], 48
    s_load_dwordx2 s[24:25], s[0:1], 40
    s_load_dwordx2 s[28:29], s[0:1], 56
    s_load_dwordx2 s[32:33], s[0:1], 64
    s_getpc_b64 s[52:53]
    v_lshlrev_b32 v1, 6, v0
    v_min_u32 v1, CODE_SPAN, v1
    global_load_dword v3, v1, s[52:53]
    s_mov_b32 s6, 2097152
    s_mov_b32 s7, 0x00020000
    s_mov_b32 s10, 1052672
    s_mov_b32 s11, 0x00020000
    s_mov_b32 s14, 1052672
    s_mov_b32 s15, 0x00020000
    s_mov_b32 s18, 1835008
    s_mov_b32 s19, 0x00020000
    s_mov_b32 s22, 1835008
    s_mov_b32 s23, 0x00020000
    s_mov_b32 s26, 3584
    s_mov_b32 s27, 0x00020000
    s_mov_b32 s30, 1024
    s_mov_b32 s31, 0x00020000
    s_mov_b32 s34, 2097152
    s_mov_b32 s35, 0x00020000
    s_mov_b32 s38, 23003136
    s_mov_b32 s39, 0x00020000
    v_lshrrev_b32 v2, 6, v0
    v_and_b32 v4, 63, v0
    v_readfirstlane_b32 s54, v2
    v_and_b32 v5, 31, v0
    v_lshrrev_b32 v6, 5, v4
    v_lshrrev_b32 v7, 4, v4
    v_and_b32 v8, 15, v0
    s_and_b32 s40, s2, 3
    s_bfe_u32 s41, s2, 0x20003
    s_lshr_b32 s48, s2, 5
    s_and_b32 s42, s2, 4
    s_lshl_b32 s42, s42, 1
    s_add_u32 s42, s42, s48
    s_lshl_b32 s46, s41, 1
    s_add_u32 s46, s46, s48
    s_and_b32 s3, s54, 3
    v_bfe_u32 v1, v4, 3, 2
    v_lshl_add_u32 v1, v1, 5, v6
    v_lshlrev_b32 v1, 10, v1
    v_and_b32 v2, 7, v4
    v_xor_b32 v2, v2, v7
    v_lshl_add_u32 v11, v2, 4, v1
    v_xor_b32 v12, 64, v11
    v_add_u32 v13, 2048, v11
    v_add_u32 v14, 3072, v12
    v_add_u32 v12, 1024, v12
    v_lshlrev_b32 v1, 2, v7
    v_xor_b32 v1, v1, v8
    v_lshlrev_b32 v2, 4, v1
    v_lshl_add_u32 v19, v7, 10, v2
    v_mul_u32_u24 v15, 3584, v7
    v_add_u32 v15, v15, v2
    s_cmp_eq_u32 s41, 3
    s_cselect_b32 s48, 8, 16
    v_cmp_gt_u32 vcc, s48, v1
    v_mov_b32 v2, 2130706432
    s_nop 0
    v_cndmask_b32 v15, v2, v15, vcc
    v_add_u32 v16, 13312, v15
    v_add_u32 v17, 26624, v15
    v_add_u32 v18, 39936, v15
    s_lshl_b32 s48, s42, 17
    s_lshl_b32 s49, s3, 13
    s_add_u32 s55, s48, s49
    s_mul_i32 s48, s3, 57344
    s_mul_i32 s49, s40, 896
    s_add_u32 s48, s48, s49
    s_lshl_b32 s49, s41, 8
    s_add_u32 s56, s48, s49
    s_mul_i32 s48, s40, 458752
    s_add_u32 s57, s48, s49
    s_lshl_b32 s58, s3, 12
    v_lshlrev_b32 v9, 4, v4
    v_cmp_eq_u32 vcc, 0, v4
    s_nop 1
    v_cndmask_b32 v10, v2, v4, vcc
    s_cmp_ge_u32 s54, 4
    s_cbranch_scc1 HELPER
    s_waitcnt lgkmcnt(0)
    s_load_dword s44, s[36:37], 0
    s_add_u32 s50, s46, 0
    s_and_b32 s50, s50, 7
    s_mul_i32 s51, s50, 229376
    s_add_u32 s51, s51, s56
    s_lshl_b32 s50, s50, 7
    s_add_u32 m0, s58, 0
    s_add_u32 s50, s50, s55
    buffer_load_dwordx4 v11, s[4:7], s50 offen offset:0 lds
    buffer_load_dwordx4 v12, s[4:7], s50 offen offset:1024 lds
    buffer_load_dwordx4 v13, s[4:7], s50 offen offset:2048 lds
    buffer_load_dwordx4 v14, s[4:7], s50 offen offset:3072 lds
    s_add_u32 m0, s58, 16384
    s_nop 0
    buffer_load_dwordx4 v15, s[16:19], s51 offen offset:0 lds
    buffer_load_dwordx4 v16, s[16:19], s51 offen offset:1024 lds
    buffer_load_dwordx4 v17, s[16:19], s51 offen offset:2048 lds
    buffer_load_dwordx4 v18, s[16:19], s51 offen offset:3072 lds
    s_lshl_b32 s43, s40, 2
    s_add_u32 s43, s43, s41
    s_mov_b32 s47, 87441936
    s_cmp_eq_u32 s41, 1
    s_cselect_b32 s47, 22045746, s47
    s_cmp_eq_u32 s41, 2
    s_cselect_b32 s47, 51512916, s47
    s_cmp_eq_u32 s41, 3
    s_cselect_b32 s47, 87114246, s47
    v_bfe_u32 v1, v5, 1, 3
    v_xor_b32 v1, v1, v6
    v_lshlrev_b32 v1, 4, v1
    v_lshl_add_u32 v1, v5, 7, v1
    v_add_u32 v23, s58, v1
    v_xor_b32 v24, 32, v23
    v_xor_b32 v25, 64, v23
    v_xor_b32 v26, 96, v23
    v_bfe_u32 v1, v4, 2, 2
    v_mul_u32_u24 v1, 320, v1
    v_lshl_add_u32 v1, v6, 11, v1
    v_and_b32 v2, 16, v4
    v_lshl_add_u32 v1, v2, 1, v1
    v_and_b32 v2, 1, v4
    v_lshl_add_u32 v1, v2, 4, v1
    v_and_b32 v2, 2, v4
    v_lshl_add_u32 v27, v2, 2, v1
    v_mov_b32 v28, 133120
    v_lshlrev_b32 v29, 4, v5
    s_lshl_b32 s48, s42, 2
    s_add_u32 s48, s48, s3
    s_lshl_b32 s48, s48, 9
    s_add_u32 s59, s48, 32768
    v_xor_b32 v30, 0, v27
    v_xor_b32 v31, 64, v27
    v_xor_b32 v32, 128, v27
    v_xor_b32 v33, 192, v27
    v_add_u32 v11, 131072, v29
    v_bfe_u32 v20, v5, 1, 1
    v_and_b32 v1, 4, v5
    v_add_u32 v20, v20, v1
    v_bfe_u32 v1, v5, 3, 1
    v_lshl_add_u32 v20, v1, 1, v20
    v_lshrrev_b32 v1, 4, v5
    v_lshl_add_u32 v20, v1, 3, v20
    s_lshl_b32 s48, s43, 4
    s_add_u32 s48, s48, 1
    v_add_u32 v20, s48, v20
    s_lshl_b32 s48, s46, 6
    s_add_u32 s48, s48, 384
    v_lshl_add_u32 v1, v6, 3, s48
    v_mul_u32_u24 v1, v1, v20
    v_and_b32 v2, 1, v5
    v_lshl_add_u32 v1, v2, 7, v1
    v_and_b32 v1, 511, v1
    v_cvt_f32_u32 v21, v1
    v_mul_f32 v21, 0x3b000000, v21
    v_cvt_f32_u32 v20, v20
    v_mul_f32 v20, 0x3b000000, v20
    v_mul_f32 v74, 0x41800000, v20
    v_cos_f32 v74, v74
    v_fmamk_f32 v12, v20, 0x00000000, v21
    v_fmamk_f32 v66, v20, 0x41800000, v21
    v_fmamk_f32 v13, v20, 0x3f800000, v21
    v_fmamk_f32 v67, v20, 0x41880000, v21
    v_fmamk_f32 v14, v20, 0x40000000, v21
    v_fmamk_f32 v68, v20, 0x41900000, v21
    v_fmamk_f32 v15, v20, 0x40400000, v21
    v_fmamk_f32 v69, v20, 0x41980000, v21
    v_fmamk_f32 v16, v20, 0x40800000, v21
    v_fmamk_f32 v70, v20, 0x41a00000, v21
    v_fmamk_f32 v17, v20, 0x40a00000, v21
    v_fmamk_f32 v71, v20, 0x41a80000, v21
    v_fmamk_f32 v18, v20, 0x40c00000, v21
    v_fmamk_f32 v72, v20, 0x41b00000, v21
    v_fmamk_f32 v19, v20, 0x40e00000, v21
    v_fmamk_f32 v73, v20, 0x41b80000, v21
    v_add_f32 v74, v74, v74
    v_cos_f32 v12, v12
    v_cos_f32 v66, v66
    v_cos_f32 v13, v13
    v_cos_f32 v67, v67
    v_cos_f32 v14, v14
    v_cos_f32 v68, v68
    v_cos_f32 v15, v15
    v_cos_f32 v69, v69
    v_cos_f32 v16, v16
    v_cos_f32 v70, v70
    v_cos_f32 v17, v17
    v_cos_f32 v71, v71
    v_cos_f32 v18, v18
    v_cos_f32 v72, v72
    v_cos_f32 v19, v19
    v_cos_f32 v73, v73
    v_cvt_pk_bf16_f32 v34, v12, v13
    v_cvt_pk_bf16_f32 v35, v14, v15
    v_cvt_pk_bf16_f32 v36, v16, v17
    v_cvt_pk_bf16_f32 v37, v18, v19
    v_pk_fma_f32 v[12:13], v[66:67], v[74:75], v[12:13] op_sel_hi:[1,0,1] neg_lo:[0,0,1] neg_hi:[0,0,1]
    v_pk_fma_f32 v[14:15], v[68:69], v[74:75], v[14:15] op_sel_hi:[1,0,1] neg_lo:[0,0,1] neg_hi:[0,0,1]
    v_pk_fma_f32 v[16:17], v[70:71], v[74:75], v[16:17] op_sel_hi:[1,0,1] neg_lo:[0,0,1] neg_hi:[0,0,1]
    v_pk_fma_f32 v[18:19], v[72:73], v[74:75], v[18:19] op_sel_hi:[1,0,1] neg_lo:[0,0,1] neg_hi:[0,0,1]
    v_cvt_pk_bf16_f32 v38, v66, v67
    v_cvt_pk_bf16_f32 v39, v68, v69
    v_cvt_pk_bf16_f32 v40, v70, v71
    v_cvt_pk_bf16_f32 v41, v72, v73
    v_pk_fma_f32 v[66:67], v[12:13], v[74:75], v[66:67] op_sel_hi:[1,0,1] neg_lo:[0,0,1] neg_hi:[0,0,1]
    v_pk_fma_f32 v[68:69], v[14:15], v[74:75], v[68:69] op_sel_hi:[1,0,1] neg_lo:[0,0,1] neg_hi:[0,0,1]
    v_pk_fma_f32 v[70:71], v[16:17], v[74:75], v[70:71] op_sel_hi:[1,0,1] neg_lo:[0,0,1] neg_hi:[0,0,1]
    v_pk_fma_f32 v[72:73], v[18:19], v[74:75], v[72:73] op_sel_hi:[1,0,1] neg_lo:[0,0,1] neg_hi:[0,0,1]
    v_cvt_pk_bf16_f32 v42, v12, v13
    v_cvt_pk_bf16_f32 v43, v14, v15
    v_cvt_pk_bf16_f32 v44, v16, v17
    v_cvt_pk_bf16_f32 v45, v18, v19
    v_pk_fma_f32 v[12:13], v[66:67], v[74:75], v[12:13] op_sel_hi:[1,0,1] neg_lo:[0,0,1] neg_hi:[0,0,1]
    v_pk_fma_f32 v[14:15], v[68:69], v[74:75], v[14:15] op_sel_hi:[1,0,1] neg_lo:[0,0,1] neg_hi:[0,0,1]
    v_pk_fma_f32 v[16:17], v[70:71], v[74:75], v[16:17] op_sel_hi:[1,0,1] neg_lo:[0,0,1] neg_hi:[0,0,1]
    v_pk_fma_f32 v[18:19], v[72:73], v[74:75], v[18:19] op_sel_hi:[1,0,1] neg_lo:[0,0,1] neg_hi:[0,0,1]
    v_cvt_pk_bf16_f32 v46, v66, v67
    v_cvt_pk_bf16_f32 v47, v68, v69
    v_cvt_pk_bf16_f32 v48, v70, v71
    v_cvt_pk_bf16_f32 v49, v72, v73
    v_pk_fma_f32 v[66:67], v[12:13], v[74:75], v[66:67] op_sel_hi:[1,0,1] neg_lo:[0,0,1] neg_hi:[0,0,1]
    v_pk_fma_f32 v[68:69], v[14:15], v[74:75], v[68:69] op_sel_hi:[1,0,1] neg_lo:[0,0,1] neg_hi:[0,0,1]
    v_pk_fma_f32 v[70:71], v[16:17], v[74:75], v[70:71] op_sel_hi:[1,0,1] neg_lo:[0,0,1] neg_hi:[0,0,1]
    v_pk_fma_f32 v[72:73], v[18:19], v[74:75], v[72:73] op_sel_hi:[1,0,1] neg_lo:[0,0,1] neg_hi:[0,0,1]
    v_cvt_pk_bf16_f32 v50, v12, v13
    v_cvt_pk_bf16_f32 v51, v14, v15
    v_cvt_pk_bf16_f32 v52, v16, v17
    v_cvt_pk_bf16_f32 v53, v18, v19
    v_pk_fma_f32 v[12:13], v[66:67], v[74:75], v[12:13] op_sel_hi:[1,0,1] neg_lo:[0,0,1] neg_hi:[0,0,1]
    v_pk_fma_f32 v[14:15], v[68:69], v[74:75], v[14:15] op_sel_hi:[1,0,1] neg_lo:[0,0,1] neg_hi:[0,0,1]
    v_pk_fma_f32 v[16:17], v[70:71], v[74:75], v[16:17] op_sel_hi:[1,0,1] neg_lo:[0,0,1] neg_hi:[0,0,1]
    v_pk_fma_f32 v[18:19], v[72:73], v[74:75], v[18:19] op_sel_hi:[1,0,1] neg_lo:[0,0,1] neg_hi:[0,0,1]
    v_cvt_pk_bf16_f32 v54, v66, v67
    v_cvt_pk_bf16_f32 v55, v68, v69
    v_cvt_pk_bf16_f32 v56, v70, v71
    v_cvt_pk_bf16_f32 v57, v72, v73
    v_pk_fma_f32 v[66:67], v[12:13], v[74:75], v[66:67] op_sel_hi:[1,0,1] neg_lo:[0,0,1] neg_hi:[0,0,1]
    v_pk_fma_f32 v[68:69], v[14:15], v[74:75], v[68:69] op_sel_hi:[1,0,1] neg_lo:[0,0,1] neg_hi:[0,0,1]
    v_pk_fma_f32 v[70:71], v[16:17], v[74:75], v[70:71] op_sel_hi:[1,0,1] neg_lo:[0,0,1] neg_hi:[0,0,1]
    v_pk_fma_f32 v[72:73], v[18:19], v[74:75], v[72:73] op_sel_hi:[1,0,1] neg_lo:[0,0,1] neg_hi:[0,0,1]
    v_cvt_pk_bf16_f32 v58, v12, v13
    v_cvt_pk_bf16_f32 v59, v14, v15
    v_cvt_pk_bf16_f32 v60, v16, v17
    v_cvt_pk_bf16_f32 v61, v18, v19
    v_cvt_pk_bf16_f32 v62, v66, v67
    v_cvt_pk_bf16_f32 v63, v68, v69
    v_cvt_pk_bf16_f32 v64, v70, v71
    v_cvt_pk_bf16_f32 v65, v72, v73
    s_lshl_b32 s48, s3, 1
    s_and_b32 s49, s3, 1
    s_add_u32 s48, s48, s49
    s_lshl_b32 s48, s48, 11
    s_add_u32 s48, s48, 98304
    v_lshlrev_b32 v1, 9, v6
    v_lshl_add_u32 v1, v5, 2, v1
    v_add_u32 v12, s48, v1
    s_waitcnt lgkmcnt(0)
    s_mul_i32 s44, s44, 1664525
    s_add_u32 s44, s44, 1013904223
    v_mov_b32 v15, s44
    s_waitcnt vmcnt(0)
    s_barrier
    ds_read_b128 v[16:19], v23 offset:0
    ds_read_b64_tr_b16 v[156:157], v30 offset:16384
    ds_read_b64_tr_b16 v[158:159], v30 offset:17408
    ds_read_b64_tr_b16 v[160:161], v31 offset:16384
    ds_read_b64_tr_b16 v[162:163], v31 offset:17408
    ds_read_b64_tr_b16 v[164:165], v32 offset:16384
    ds_read_b64_tr_b16 v[166:167], v32 offset:17408
    ds_read_b64_tr_b16 v[168:169], v33 offset:16384
    ds_read_b64_tr_b16 v[170:171], v33 offset:17408
    s_waitcnt lgkmcnt(8)
    v_mfma_f32_32x32x16_bf16 v[76:91], v[34:37], v[16:19], 0
    ds_read_b128 v[66:69], v24 offset:0
    ds_read_b64_tr_b16 v[172:173], v30 offset:20480
    ds_read_b64_tr_b16 v[174:175], v30 offset:21504
    s_waitcnt lgkmcnt(9)
    v_mfma_f32_32x32x16_bf16 v[92:107], v[156:159], v[16:19], 0
    ds_read_b64_tr_b16 v[176:177], v31 offset:20480
    ds_read_b64_tr_b16 v[178:179], v31 offset:21504
    s_waitcnt lgkmcnt(9)
    v_mfma_f32_32x32x16_bf16 v[108:123], v[160:163], v[16:19], 0
    ds_read_b64_tr_b16 v[180:181], v32 offset:20480
    ds_read_b64_tr_b16 v[182:183], v32 offset:21504
    s_waitcnt lgkmcnt(9)
    v_mfma_f32_32x32x16_bf16 v[124:139], v[164:167], v[16:19], 0
    ds_read_b64_tr_b16 v[184:185], v33 offset:20480
    ds_read_b64_tr_b16 v[186:187], v33 offset:21504
    s_waitcnt lgkmcnt(9)
    v_mfma_f32_32x32x16_bf16 v[140:155], v[168:171], v[16:19], 0
    s_waitcnt lgkmcnt(8)
    v_mfma_f32_32x32x16_bf16 v[76:91], v[38:41], v[66:69], v[76:91]
    ds_read_b128 v[16:19], v25 offset:0
    ds_read_b64_tr_b16 v[156:157], v30 offset:24576
    ds_read_b64_tr_b16 v[158:159], v30 offset:25600
    s_waitcnt lgkmcnt(9)
    v_mfma_f32_32x32x16_bf16 v[92:107], v[172:175], v[66:69], v[92:107]
    ds_read_b64_tr_b16 v[160:161], v31 offset:24576
    ds_read_b64_tr_b16 v[162:163], v31 offset:25600
    s_waitcnt lgkmcnt(9)
    v_mfma_f32_32x32x16_bf16 v[108:123], v[176:179], v[66:69], v[108:123]
    ds_read_b64_tr_b16 v[164:165], v32 offset:24576
    ds_read_b64_tr_b16 v[166:167], v32 offset:25600
    s_waitcnt lgkmcnt(9)
    v_mfma_f32_32x32x16_bf16 v[124:139], v[180:183], v[66:69], v[124:139]
    ds_read_b64_tr_b16 v[168:169], v33 offset:24576
    ds_read_b64_tr_b16 v[170:171], v33 offset:25600
    s_waitcnt lgkmcnt(9)
    v_mfma_f32_32x32x16_bf16 v[140:155], v[184:187], v[66:69], v[140:155]
    s_waitcnt lgkmcnt(8)
    v_mfma_f32_32x32x16_bf16 v[76:91], v[42:45], v[16:19], v[76:91]
    ds_read_b128 v[66:69], v26 offset:0
    ds_read_b64_tr_b16 v[172:173], v30 offset:28672
    ds_read_b64_tr_b16 v[174:175], v30 offset:29696
    s_waitcnt lgkmcnt(9)
    v_mfma_f32_32x32x16_bf16 v[92:107], v[156:159], v[16:19], v[92:107]
    ds_read_b64_tr_b16 v[176:177], v31 offset:28672
    ds_read_b64_tr_b16 v[178:179], v31 offset:29696
    s_waitcnt lgkmcnt(9)
    v_mfma_f32_32x32x16_bf16 v[108:123], v[160:163], v[16:19], v[108:123]
    ds_read_b64_tr_b16 v[180:181], v32 offset:28672
    ds_read_b64_tr_b16 v[182:183], v32 offset:29696
    s_waitcnt lgkmcnt(9)
    v_mfma_f32_32x32x16_bf16 v[124:139], v[164:167], v[16:19], v[124:139]
    ds_read_b64_tr_b16 v[184:185], v33 offset:28672
    ds_read_b64_tr_b16 v[186:187], v33 offset:29696
    s_waitcnt lgkmcnt(9)
    v_mfma_f32_32x32x16_bf16 v[140:155], v[168:171], v[16:19], v[140:155]
    s_barrier
    s_waitcnt lgkmcnt(8)
    v_mfma_f32_32x32x16_bf16 v[76:91], v[46:49], v[66:69], v[76:91]
    ds_read_b128 v[16:19], v23 offset:32768
    ds_read_b64_tr_b16 v[156:157], v30 offset:49152
    ds_read_b64_tr_b16 v[158:159], v30 offset:50176
    s_waitcnt lgkmcnt(9)
    v_mfma_f32_32x32x16_bf16 v[92:107], v[172:175], v[66:69], v[92:107]
    ds_read_b64_tr_b16 v[160:161], v31 offset:49152
    ds_read_b64_tr_b16 v[162:163], v31 offset:50176
    s_waitcnt lgkmcnt(9)
    v_mfma_f32_32x32x16_bf16 v[108:123], v[176:179], v[66:69], v[108:123]
    ds_read_b64_tr_b16 v[164:165], v32 offset:49152
    ds_read_b64_tr_b16 v[166:167], v32 offset:50176
    s_waitcnt lgkmcnt(9)
    v_mfma_f32_32x32x16_bf16 v[124:139], v[180:183], v[66:69], v[124:139]
    ds_read_b64_tr_b16 v[168:169], v33 offset:49152
    ds_read_b64_tr_b16 v[170:171], v33 offset:50176
    s_waitcnt lgkmcnt(9)
    v_mfma_f32_32x32x16_bf16 v[140:155], v[184:187], v[66:69], v[140:155]
    s_waitcnt lgkmcnt(8)
    v_mfma_f32_32x32x16_bf16 v[76:91], v[50:53], v[16:19], v[76:91]
    ds_read_b128 v[66:69], v24 offset:32768
    ds_read_b64_tr_b16 v[172:173], v30 offset:53248
    ds_read_b64_tr_b16 v[174:175], v30 offset:54272
    s_waitcnt lgkmcnt(9)
    v_mfma_f32_32x32x16_bf16 v[92:107], v[156:159], v[16:19], v[92:107]
    ds_read_b64_tr_b16 v[176:177], v31 offset:53248
    ds_read_b64_tr_b16 v[178:179], v31 offset:54272
    s_waitcnt lgkmcnt(9)
    v_mfma_f32_32x32x16_bf16 v[108:123], v[160:163], v[16:19], v[108:123]
    ds_read_b64_tr_b16 v[180:181], v32 offset:53248
    ds_read_b64_tr_b16 v[182:183], v32 offset:54272
    s_waitcnt lgkmcnt(9)
    v_mfma_f32_32x32x16_bf16 v[124:139], v[164:167], v[16:19], v[124:139]
    ds_read_b64_tr_b16 v[184:185], v33 offset:53248
    ds_read_b64_tr_b16 v[186:187], v33 offset:54272
    s_waitcnt lgkmcnt(9)
    v_mfma_f32_32x32x16_bf16 v[140:155], v[168:171], v[16:19], v[140:155]
    s_waitcnt lgkmcnt(8)
    v_mfma_f32_32x32x16_bf16 v[76:91], v[54:57], v[66:69], v[76:91]
    ds_read_b128 v[16:19], v25 offset:32768
    ds_read_b64_tr_b16 v[156:157], v30 offset:57344
    ds_read_b64_tr_b16 v[158:159], v30 offset:58368
    s_waitcnt lgkmcnt(9)
    v_mfma_f32_32x32x16_bf16 v[92:107], v[172:175], v[66:69], v[92:107]
    ds_read_b64_tr_b16 v[160:161], v31 offset:57344
    ds_read_b64_tr_b16 v[162:163], v31 offset:58368
    s_waitcnt lgkmcnt(9)
    v_mfma_f32_32x32x16_bf16 v[108:123], v[176:179], v[66:69], v[108:123]
    ds_read_b64_tr_b16 v[164:165], v32 offset:57344
    ds_read_b64_tr_b16 v[166:167], v32 offset:58368
    s_waitcnt lgkmcnt(9)
    v_mfma_f32_32x32x16_bf16 v[124:139], v[180:183], v[66:69], v[124:139]
    ds_read_b64_tr_b16 v[168:169], v33 offset:57344
    ds_read_b64_tr_b16 v[170:171], v33 offset:58368
    s_waitcnt lgkmcnt(9)
    v_mfma_f32_32x32x16_bf16 v[140:155], v[184:187], v[66:69], v[140:155]
    s_waitcnt lgkmcnt(8)
    v_mfma_f32_32x32x16_bf16 v[76:91], v[58:61], v[16:19], v[76:91]
    ds_read_b128 v[66:69], v26 offset:32768
    ds_read_b64_tr_b16 v[172:173], v30 offset:61440
    ds_read_b64_tr_b16 v[174:175], v30 offset:62464
    s_waitcnt lgkmcnt(9)
    v_mfma_f32_32x32x16_bf16 v[92:107], v[156:159], v[16:19], v[92:107]
    ds_read_b64_tr_b16 v[176:177], v31 offset:61440
    ds_read_b64_tr_b16 v[178:179], v31 offset:62464
    s_waitcnt lgkmcnt(9)
    v_mfma_f32_32x32x16_bf16 v[108:123], v[160:163], v[16:19], v[108:123]
    ds_read_b64_tr_b16 v[180:181], v32 offset:61440
    ds_read_b64_tr_b16 v[182:183], v32 offset:62464
    s_waitcnt lgkmcnt(9)
    v_mfma_f32_32x32x16_bf16 v[124:139], v[164:167], v[16:19], v[124:139]
    ds_read_b64_tr_b16 v[184:185], v33 offset:61440
    ds_read_b64_tr_b16 v[186:187], v33 offset:62464
    v_xor_b32 v23, 0x10000, v23
    v_xor_b32 v24, 0x10000, v24
    v_xor_b32 v25, 0x10000, v25
    v_xor_b32 v26, 0x10000, v26
    s_waitcnt lgkmcnt(9)
    v_mfma_f32_32x32x16_bf16 v[140:155], v[168:171], v[16:19], v[140:155]
    v_xor_b32 v30, 0x10000, v30
    v_xor_b32 v31, 0x10000, v31
    v_xor_b32 v32, 0x10000, v32
    v_xor_b32 v33, 0x10000, v33
    s_barrier
    s_waitcnt lgkmcnt(8)
    v_mfma_f32_32x32x16_bf16 v[76:91], v[62:65], v[66:69], v[76:91]
    ds_read_b128 v[16:19], v23 offset:0
    ds_read_b64_tr_b16 v[156:157], v30 offset:16384
    ds_read_b64_tr_b16 v[158:159], v30 offset:17408
    s_waitcnt lgkmcnt(9)
    v_mfma_f32_32x32x16_bf16 v[92:107], v[172:175], v[66:69], v[92:107]
    ds_read_b64_tr_b16 v[160:161], v31 offset:16384
    ds_read_b64_tr_b16 v[162:163], v31 offset:17408
    s_waitcnt lgkmcnt(9)
    v_mfma_f32_32x32x16_bf16 v[108:123], v[176:179], v[66:69], v[108:123]
    ds_read_b64_tr_b16 v[164:165], v32 offset:16384
    ds_read_b64_tr_b16 v[166:167], v32 offset:17408
    s_waitcnt lgkmcnt(9)
    v_mfma_f32_32x32x16_bf16 v[124:139], v[180:183], v[66:69], v[124:139]
    ds_read_b64_tr_b16 v[168:169], v33 offset:16384
    ds_read_b64_tr_b16 v[170:171], v33 offset:17408
    v_swap_b32 v76, v77
    v_xor_b32 v76, 0x80000000, v76
    v_xor_b32 v78, 0x80000000, v78
    v_xor_b32 v79, 0x80000000, v79
    v_swap_b32 v80, v81
    v_xor_b32 v81, 0x80000000, v81
    s_waitcnt lgkmcnt(9)
    v_mfma_f32_32x32x16_bf16 v[140:155], v[184:187], v[66:69], v[140:155]
    v_swap_b32 v84, v85
    v_xor_b32 v84, 0x80000000, v84
    v_xor_b32 v86, 0x80000000, v86
    v_xor_b32 v87, 0x80000000, v87
    v_swap_b32 v88, v89
    v_xor_b32 v89, 0x80000000, v89
    s_waitcnt lgkmcnt(8)
    s_nop 0
    v_mfma_f32_32x32x16_bf16 v[76:91], v[34:37], v[16:19], v[76:91]
    ds_read_b128 v[66:69], v24 offset:0
    ds_read_b64_tr_b16 v[172:173], v30 offset:20480
    ds_read_b64_tr_b16 v[174:175], v30 offset:21504
    s_waitcnt lgkmcnt(9)
    v_mfma_f32_32x32x16_bf16 v[92:107], v[156:159], v[16:19], v[92:107]
    ds_read_b64_tr_b16 v[176:177], v31 offset:20480
    ds_read_b64_tr_b16 v[178:179], v31 offset:21504
    s_waitcnt lgkmcnt(9)
    v_mfma_f32_32x32x16_bf16 v[108:123], v[160:163], v[16:19], v[108:123]
    ds_read_b64_tr_b16 v[180:181], v32 offset:20480
    ds_read_b64_tr_b16 v[182:183], v32 offset:21504
    s_waitcnt lgkmcnt(9)
    v_mfma_f32_32x32x16_bf16 v[124:139], v[164:167], v[16:19], v[124:139]
    ds_read_b64_tr_b16 v[184:185], v33 offset:20480
    ds_read_b64_tr_b16 v[186:187], v33 offset:21504
    s_waitcnt lgkmcnt(9)
    v_mfma_f32_32x32x16_bf16 v[140:155], v[168:171], v[16:19], v[140:155]
    s_waitcnt lgkmcnt(8)
    v_mfma_f32_32x32x16_bf16 v[76:91], v[38:41], v[66:69], v[76:91]
    ds_read_b128 v[16:19], v25 offset:0
    ds_read_b64_tr_b16 v[156:157], v30 offset:24576
    ds_read_b64_tr_b16 v[158:159], v30 offset:25600
    s_waitcnt lgkmcnt(9)
    v_mfma_f32_32x32x16_bf16 v[92:107], v[172:175], v[66:69], v[92:107]
    ds_read_b64_tr_b16 v[160:161], v31 offset:24576
    ds_read_b64_tr_b16 v[162:163], v31 offset:25600
    s_waitcnt lgkmcnt(9)
    v_mfma_f32_32x32x16_bf16 v[108:123], v[176:179], v[66:69], v[108:123]
    ds_read_b64_tr_b16 v[164:165], v32 offset:24576
    ds_read_b64_tr_b16 v[166:167], v32 offset:25600
    s_waitcnt lgkmcnt(9)
    v_mfma_f32_32x32x16_bf16 v[124:139], v[180:183], v[66:69], v[124:139]
    ds_read_b64_tr_b16 v[168:169], v33 offset:24576
    ds_read_b64_tr_b16 v[170:171], v33 offset:25600
    s_waitcnt lgkmcnt(9)
    v_mfma_f32_32x32x16_bf16 v[140:155], v[184:187], v[66:69], v[140:155]
    s_waitcnt lgkmcnt(8)
    v_mfma_f32_32x32x16_bf16 v[76:91], v[42:45], v[16:19], v[76:91]
    ds_read_b128 v[66:69], v26 offset:0
    ds_read_b64_tr_b16 v[172:173], v30 offset:28672
    ds_read_b64_tr_b16 v[174:175], v30 offset:29696
    s_waitcnt lgkmcnt(9)
    v_mfma_f32_32x32x16_bf16 v[92:107], v[156:159], v[16:19], v[92:107]
    ds_read_b64_tr_b16 v[176:177], v31 offset:28672
    ds_read_b64_tr_b16 v[178:179], v31 offset:29696
    s_waitcnt lgkmcnt(9)
    v_mfma_f32_32x32x16_bf16 v[108:123], v[160:163], v[16:19], v[108:123]
    ds_read_b64_tr_b16 v[180:181], v32 offset:28672
    ds_read_b64_tr_b16 v[182:183], v32 offset:29696
    s_waitcnt lgkmcnt(9)
    v_mfma_f32_32x32x16_bf16 v[124:139], v[164:167], v[16:19], v[124:139]
    ds_read_b64_tr_b16 v[184:185], v33 offset:28672
    ds_read_b64_tr_b16 v[186:187], v33 offset:29696
    s_waitcnt lgkmcnt(9)
    v_mfma_f32_32x32x16_bf16 v[140:155], v[168:171], v[16:19], v[140:155]
    s_barrier
    s_waitcnt lgkmcnt(8)
    v_mfma_f32_32x32x16_bf16 v[76:91], v[46:49], v[66:69], v[76:91]
    ds_read_b128 v[16:19], v23 offset:32768
    ds_read_b64_tr_b16 v[156:157], v30 offset:49152
    ds_read_b64_tr_b16 v[158:159], v30 offset:50176
    s_waitcnt lgkmcnt(9)
    v_mfma_f32_32x32x16_bf16 v[92:107], v[172:175], v[66:69], v[92:107]
    ds_read_b64_tr_b16 v[160:161], v31 offset:49152
    ds_read_b64_tr_b16 v[162:163], v31 offset:50176
    s_waitcnt lgkmcnt(9)
    v_mfma_f32_32x32x16_bf16 v[108:123], v[176:179], v[66:69], v[108:123]
    ds_read_b64_tr_b16 v[164:165], v32 offset:49152
    ds_read_b64_tr_b16 v[166:167], v32 offset:50176
    s_waitcnt lgkmcnt(9)
    v_mfma_f32_32x32x16_bf16 v[124:139], v[180:183], v[66:69], v[124:139]
    ds_read_b64_tr_b16 v[168:169], v33 offset:49152
    ds_read_b64_tr_b16 v[170:171], v33 offset:50176
    s_waitcnt lgkmcnt(9)
    v_mfma_f32_32x32x16_bf16 v[140:155], v[184:187], v[66:69], v[140:155]
    s_waitcnt lgkmcnt(8)
    v_mfma_f32_32x32x16_bf16 v[76:91], v[50:53], v[16:19], v[76:91]
    ds_read_b128 v[66:69], v24 offset:32768
    ds_read_b64_tr_b16 v[172:173], v30 offset:53248
    ds_read_b64_tr_b16 v[174:175], v30 offset:54272
    s_waitcnt lgkmcnt(9)
    v_mfma_f32_32x32x16_bf16 v[92:107], v[156:159], v[16:19], v[92:107]
    ds_read_b64_tr_b16 v[176:177], v31 offset:53248
    ds_read_b64_tr_b16 v[178:179], v31 offset:54272
    s_waitcnt lgkmcnt(9)
    v_mfma_f32_32x32x16_bf16 v[108:123], v[160:163], v[16:19], v[108:123]
    ds_read_b64_tr_b16 v[180:181], v32 offset:53248
    ds_read_b64_tr_b16 v[182:183], v32 offset:54272
    s_waitcnt lgkmcnt(9)
    v_mfma_f32_32x32x16_bf16 v[124:139], v[164:167], v[16:19], v[124:139]
    ds_read_b64_tr_b16 v[184:185], v33 offset:53248
    ds_read_b64_tr_b16 v[186:187], v33 offset:54272
    s_waitcnt lgkmcnt(9)
    v_mfma_f32_32x32x16_bf16 v[140:155], v[168:171], v[16:19], v[140:155]
    s_waitcnt lgkmcnt(8)
    v_mfma_f32_32x32x16_bf16 v[76:91], v[54:57], v[66:69], v[76:91]
    ds_read_b128 v[16:19], v25 offset:32768
    ds_read_b64_tr_b16 v[156:157], v30 offset:57344
    ds_read_b64_tr_b16 v[158:159], v30 offset:58368
    s_waitcnt lgkmcnt(9)
    v_mfma_f32_32x32x16_bf16 v[92:107], v[172:175], v[66:69], v[92:107]
    ds_read_b64_tr_b16 v[160:161], v31 offset:57344
    ds_read_b64_tr_b16 v[162:163], v31 offset:58368
    s_waitcnt lgkmcnt(9)
    v_mfma_f32_32x32x16_bf16 v[108:123], v[176:179], v[66:69], v[108:123]
    ds_read_b64_tr_b16 v[164:165], v32 offset:57344
    ds_read_b64_tr_b16 v[166:167], v32 offset:58368
    s_waitcnt lgkmcnt(9)
    v_mfma_f32_32x32x16_bf16 v[124:139], v[180:183], v[66:69], v[124:139]
    ds_read_b64_tr_b16 v[168:169], v33 offset:57344
    ds_read_b64_tr_b16 v[170:171], v33 offset:58368
    s_waitcnt lgkmcnt(9)
    v_mfma_f32_32x32x16_bf16 v[140:155], v[184:187], v[66:69], v[140:155]
    s_waitcnt lgkmcnt(8)
    v_mfma_f32_32x32x16_bf16 v[76:91], v[58:61], v[16:19], v[76:91]
    ds_read_b128 v[66:69], v26 offset:32768
    ds_read_b64_tr_b16 v[172:173], v30 offset:61440
    ds_read_b64_tr_b16 v[174:175], v30 offset:62464
    s_waitcnt lgkmcnt(9)
    v_mfma_f32_32x32x16_bf16 v[92:107], v[156:159], v[16:19], v[92:107]
    ds_read_b64_tr_b16 v[176:177], v31 offset:61440
    ds_read_b64_tr_b16 v[178:179], v31 offset:62464
    s_waitcnt lgkmcnt(9)
    v_mfma_f32_32x32x16_bf16 v[108:123], v[160:163], v[16:19], v[108:123]
    ds_read_b64_tr_b16 v[180:181], v32 offset:61440
    ds_read_b64_tr_b16 v[182:183], v32 offset:62464
    s_waitcnt lgkmcnt(9)
    v_mfma_f32_32x32x16_bf16 v[124:139], v[164:167], v[16:19], v[124:139]
    ds_read_b64_tr_b16 v[184:185], v33 offset:61440
    ds_read_b64_tr_b16 v[186:187], v33 offset:62464
    v_xor_b32 v23, 0x10000, v23
    v_xor_b32 v24, 0x10000, v24
    v_xor_b32 v25, 0x10000, v25
    v_xor_b32 v26, 0x10000, v26
    s_waitcnt lgkmcnt(9)
    v_mfma_f32_32x32x16_bf16 v[140:155], v[168:171], v[16:19], v[140:155]
    v_xor_b32 v30, 0x10000, v30
    v_xor_b32 v31, 0x10000, v31
    v_xor_b32 v32, 0x10000, v32
    v_xor_b32 v33, 0x10000, v33
    buffer_load_dwordx4 v[70:73], v29, s[36:39], s59 offen sc1
    s_barrier
    s_waitcnt lgkmcnt(8)
    v_mfma_f32_32x32x16_bf16 v[76:91], v[62:65], v[66:69], v[76:91]
    ds_read_b128 v[16:19], v23 offset:0
    ds_read_b64_tr_b16 v[156:157], v30 offset:16384
    ds_read_b64_tr_b16 v[158:159], v30 offset:17408
    s_waitcnt lgkmcnt(9)
    v_mfma_f32_32x32x16_bf16 v[92:107], v[172:175], v[66:69], v[92:107]
    ds_read_b64_tr_b16 v[160:161], v31 offset:16384
    ds_read_b64_tr_b16 v[162:163], v31 offset:17408
    s_waitcnt lgkmcnt(9)
    v_mfma_f32_32x32x16_bf16 v[108:123], v[176:179], v[66:69], v[108:123]
    ds_read_b64_tr_b16 v[164:165], v32 offset:16384
    ds_read_b64_tr_b16 v[166:167], v32 offset:17408
    s_waitcnt lgkmcnt(9)
    v_mfma_f32_32x32x16_bf16 v[124:139], v[180:183], v[66:69], v[124:139]
    ds_read_b64_tr_b16 v[168:169], v33 offset:16384
    ds_read_b64_tr_b16 v[170:171], v33 offset:17408
    v_swap_b32 v76, v77
    v_xor_b32 v76, 0x80000000, v76
    v_xor_b32 v78, 0x80000000, v78
    v_xor_b32 v79, 0x80000000, v79
    v_swap_b32 v80, v81
    v_xor_b32 v81, 0x80000000, v81
    s_waitcnt lgkmcnt(9)
    v_mfma_f32_32x32x16_bf16 v[140:155], v[184:187], v[66:69], v[140:155]
    v_swap_b32 v84, v85
    v_xor_b32 v84, 0x80000000, v84
    v_xor_b32 v86, 0x80000000, v86
    v_xor_b32 v87, 0x80000000, v87
    v_swap_b32 v88, v89
    v_xor_b32 v89, 0x80000000, v89
    s_waitcnt lgkmcnt(8)
    s_nop 0
    v_mfma_f32_32x32x16_bf16 v[76:91], v[34:37], v[16:19], v[76:91]
    ds_read_b128 v[66:69], v24 offset:0
    ds_read_b64_tr_b16 v[172:173], v30 offset:20480
    ds_read_b64_tr_b16 v[174:175], v30 offset:21504
    s_waitcnt lgkmcnt(9)
    v_mfma_f32_32x32x16_bf16 v[92:107], v[156:159], v[16:19], v[92:107]
    ds_read_b64_tr_b16 v[176:177], v31 offset:20480
    ds_read_b64_tr_b16 v[178:179], v31 offset:21504
    s_waitcnt lgkmcnt(9)
    v_mfma_f32_32x32x16_bf16 v[108:123], v[160:163], v[16:19], v[108:123]
    ds_read_b64_tr_b16 v[180:181], v32 offset:20480
    ds_read_b64_tr_b16 v[182:183], v32 offset:21504
    s_waitcnt lgkmcnt(9)
    v_mfma_f32_32x32x16_bf16 v[124:139], v[164:167], v[16:19], v[124:139]
    ds_read_b64_tr_b16 v[184:185], v33 offset:20480
    ds_read_b64_tr_b16 v[186:187], v33 offset:21504
    s_waitcnt lgkmcnt(9)
    v_mfma_f32_32x32x16_bf16 v[140:155], v[168:171], v[16:19], v[140:155]
    s_waitcnt lgkmcnt(8)
    v_mfma_f32_32x32x16_bf16 v[76:91], v[38:41], v[66:69], v[76:91]
    ds_read_b128 v[16:19], v25 offset:0
    ds_read_b64_tr_b16 v[156:157], v30 offset:24576
    ds_read_b64_tr_b16 v[158:159], v30 offset:25600
    s_waitcnt lgkmcnt(9)
    v_mfma_f32_32x32x16_bf16 v[92:107], v[172:175], v[66:69], v[92:107]
    ds_read_b64_tr_b16 v[160:161], v31 offset:24576
    ds_read_b64_tr_b16 v[162:163], v31 offset:25600
    s_waitcnt lgkmcnt(9)
    v_mfma_f32_32x32x16_bf16 v[108:123], v[176:179], v[66:69], v[108:123]
    ds_read_b64_tr_b16 v[164:165], v32 offset:24576
    ds_read_b64_tr_b16 v[166:167], v32 offset:25600
    s_waitcnt lgkmcnt(9)
    v_mfma_f32_32x32x16_bf16 v[124:139], v[180:183], v[66:69], v[124:139]
    ds_read_b64_tr_b16 v[168:169], v33 offset:24576
    ds_read_b64_tr_b16 v[170:171], v33 offset:25600
    s_waitcnt lgkmcnt(9)
    v_mfma_f32_32x32x16_bf16 v[140:155], v[184:187], v[66:69], v[140:155]
    s_waitcnt lgkmcnt(8)
    v_mfma_f32_32x32x16_bf16 v[76:91], v[42:45], v[16:19], v[76:91]
    ds_read_b128 v[66:69], v26 offset:0
    ds_read_b64_tr_b16 v[172:173], v30 offset:28672
    ds_read_b64_tr_b16 v[174:175], v30 offset:29696
    s_waitcnt lgkmcnt(9)
    v_mfma_f32_32x32x16_bf16 v[92:107], v[156:159], v[16:19], v[92:107]
    ds_read_b64_tr_b16 v[176:177], v31 offset:28672
    ds_read_b64_tr_b16 v[178:179], v31 offset:29696
    s_waitcnt lgkmcnt(9)
    v_mfma_f32_32x32x16_bf16 v[108:123], v[160:163], v[16:19], v[108:123]
    ds_read_b64_tr_b16 v[180:181], v32 offset:28672
    ds_read_b64_tr_b16 v[182:183], v32 offset:29696
    s_waitcnt lgkmcnt(9)
    v_mfma_f32_32x32x16_bf16 v[124:139], v[164:167], v[16:19], v[124:139]
    ds_read_b64_tr_b16 v[184:185], v33 offset:28672
    ds_read_b64_tr_b16 v[186:187], v33 offset:29696
    s_waitcnt lgkmcnt(9)
    v_mfma_f32_32x32x16_bf16 v[140:155], v[168:171], v[16:19], v[140:155]
    s_barrier
    s_waitcnt lgkmcnt(8)
    v_mfma_f32_32x32x16_bf16 v[76:91], v[46:49], v[66:69], v[76:91]
    ds_read_b128 v[16:19], v23 offset:32768
    ds_read_b64_tr_b16 v[156:157], v30 offset:49152
    ds_read_b64_tr_b16 v[158:159], v30 offset:50176
    s_waitcnt lgkmcnt(9)
    v_mfma_f32_32x32x16_bf16 v[92:107], v[172:175], v[66:69], v[92:107]
    ds_read_b64_tr_b16 v[160:161], v31 offset:49152
    ds_read_b64_tr_b16 v[162:163], v31 offset:50176
    s_waitcnt lgkmcnt(9)
    v_mfma_f32_32x32x16_bf16 v[108:123], v[176:179], v[66:69], v[108:123]
    ds_read_b64_tr_b16 v[164:165], v32 offset:49152
    ds_read_b64_tr_b16 v[166:167], v32 offset:50176
    s_waitcnt lgkmcnt(9)
    v_mfma_f32_32x32x16_bf16 v[124:139], v[180:183], v[66:69], v[124:139]
    ds_read_b64_tr_b16 v[168:169], v33 offset:49152
    ds_read_b64_tr_b16 v[170:171], v33 offset:50176
    s_waitcnt lgkmcnt(9)
    v_mfma_f32_32x32x16_bf16 v[140:155], v[184:187], v[66:69], v[140:155]
    s_waitcnt lgkmcnt(8)
    v_mfma_f32_32x32x16_bf16 v[76:91], v[50:53], v[16:19], v[76:91]
    ds_read_b128 v[66:69], v24 offset:32768
    ds_read_b64_tr_b16 v[172:173], v30 offset:53248
    ds_read_b64_tr_b16 v[174:175], v30 offset:54272
    s_waitcnt lgkmcnt(9)
    v_mfma_f32_32x32x16_bf16 v[92:107], v[156:159], v[16:19], v[92:107]
    ds_read_b64_tr_b16 v[176:177], v31 offset:53248
    ds_read_b64_tr_b16 v[178:179], v31 offset:54272
    s_waitcnt lgkmcnt(9)
    v_mfma_f32_32x32x16_bf16 v[108:123], v[160:163], v[16:19], v[108:123]
    ds_read_b64_tr_b16 v[180:181], v32 offset:53248
    ds_read_b64_tr_b16 v[182:183], v32 offset:54272
    s_waitcnt lgkmcnt(9)
    v_mfma_f32_32x32x16_bf16 v[124:139], v[164:167], v[16:19], v[124:139]
    ds_read_b64_tr_b16 v[184:185], v33 offset:53248
    ds_read_b64_tr_b16 v[186:187], v33 offset:54272
    s_waitcnt lgkmcnt(9)
    v_mfma_f32_32x32x16_bf16 v[140:155], v[168:171], v[16:19], v[140:155]
    s_waitcnt lgkmcnt(8)
    v_mfma_f32_32x32x16_bf16 v[76:91], v[54:57], v[66:69], v[76:91]
    ds_read_b128 v[16:19], v25 offset:32768
    ds_read_b64_tr_b16 v[156:157], v30 offset:57344
    ds_read_b64_tr_b16 v[158:159], v30 offset:58368
    s_waitcnt lgkmcnt(9)
    v_mfma_f32_32x32x16_bf16 v[92:107], v[172:175], v[66:69], v[92:107]
    ds_read_b64_tr_b16 v[160:161], v31 offset:57344
    ds_read_b64_tr_b16 v[162:163], v31 offset:58368
    s_waitcnt lgkmcnt(9)
    v_mfma_f32_32x32x16_bf16 v[108:123], v[176:179], v[66:69], v[108:123]
    ds_read_b64_tr_b16 v[164:165], v32 offset:57344
    ds_read_b64_tr_b16 v[166:167], v32 offset:58368
    s_waitcnt lgkmcnt(9)
    v_mfma_f32_32x32x16_bf16 v[124:139], v[180:183], v[66:69], v[124:139]
    ds_read_b64_tr_b16 v[168:169], v33 offset:57344
    ds_read_b64_tr_b16 v[170:171], v33 offset:58368
    s_waitcnt lgkmcnt(9)
    v_mfma_f32_32x32x16_bf16 v[140:155], v[184:187], v[66:69], v[140:155]
    s_waitcnt lgkmcnt(8)
    v_mfma_f32_32x32x16_bf16 v[76:91], v[58:61], v[16:19], v[76:91]
    ds_read_b128 v[66:69], v26 offset:32768
    ds_read_b64_tr_b16 v[172:173], v30 offset:61440
    ds_read_b64_tr_b16 v[174:175], v30 offset:62464
    s_waitcnt lgkmcnt(9)
    v_mfma_f32_32x32x16_bf16 v[92:107], v[156:159], v[16:19], v[92:107]
    ds_read_b64_tr_b16 v[176:177], v31 offset:61440
    ds_read_b64_tr_b16 v[178:179], v31 offset:62464
    s_waitcnt lgkmcnt(9)
    v_mfma_f32_32x32x16_bf16 v[108:123], v[160:163], v[16:19], v[108:123]
    ds_read_b64_tr_b16 v[180:181], v32 offset:61440
    ds_read_b64_tr_b16 v[182:183], v32 offset:62464
    s_waitcnt lgkmcnt(9)
    v_mfma_f32_32x32x16_bf16 v[124:139], v[164:167], v[16:19], v[124:139]
    ds_read_b64_tr_b16 v[184:185], v33 offset:61440
    ds_read_b64_tr_b16 v[186:187], v33 offset:62464
    v_xor_b32 v23, 0x10000, v23
    v_xor_b32 v24, 0x10000, v24
    v_xor_b32 v25, 0x10000, v25
    v_xor_b32 v26, 0x10000, v26
    s_waitcnt lgkmcnt(9)
    v_mfma_f32_32x32x16_bf16 v[140:155], v[168:171], v[16:19], v[140:155]
    v_xor_b32 v30, 0x10000, v30
    v_xor_b32 v31, 0x10000, v31
    v_xor_b32 v32, 0x10000, v32
    v_xor_b32 v33, 0x10000, v33
    s_barrier
    s_waitcnt lgkmcnt(8)
    v_mfma_f32_32x32x16_bf16 v[76:91], v[62:65], v[66:69], v[76:91]
    ds_read_b128 v[16:19], v23 offset:0
    ds_read_b64_tr_b16 v[156:157], v30 offset:16384
    ds_read_b64_tr_b16 v[158:159], v30 offset:17408
    s_waitcnt lgkmcnt(9)
    v_mfma_f32_32x32x16_bf16 v[92:107], v[172:175], v[66:69], v[92:107]
    ds_read_b64_tr_b16 v[160:161], v31 offset:16384
    ds_read_b64_tr_b16 v[162:163], v31 offset:17408
    s_waitcnt lgkmcnt(9)
    v_mfma_f32_32x32x16_bf16 v[108:123], v[176:179], v[66:69], v[108:123]
    ds_read_b64_tr_b16 v[164:165], v32 offset:16384
    ds_read_b64_tr_b16 v[166:167], v32 offset:17408
    s_waitcnt lgkmcnt(9)
    v_mfma_f32_32x32x16_bf16 v[124:139], v[180:183], v[66:69], v[124:139]
    ds_read_b64_tr_b16 v[168:169], v33 offset:16384
    ds_read_b64_tr_b16 v[170:171], v33 offset:17408
    v_swap_b32 v76, v77
    v_xor_b32 v76, 0x80000000, v76
    v_xor_b32 v78, 0x80000000, v78
    v_xor_b32 v79, 0x80000000, v79
    v_swap_b32 v80, v81
    v_xor_b32 v81, 0x80000000, v81
    s_waitcnt lgkmcnt(9)
    v_mfma_f32_32x32x16_bf16 v[140:155], v[184:187], v[66:69], v[140:155]
    v_swap_b32 v84, v85
    v_xor_b32 v84, 0x80000000, v84
    v_xor_b32 v86, 0x80000000, v86
    v_xor_b32 v87, 0x80000000, v87
    v_swap_b32 v88, v89
    v_xor_b32 v89, 0x80000000, v89
    s_mov_b32 s45, 65536
    s_waitcnt vmcnt(0)
POLL_1:
    v_xor_b32 v1, s44, v71
    v_xor_b32 v2, s44, v73
    v_or_b32 v1, v1, v2
    v_cmp_ne_u32 vcc, 0, v1
    s_sub_u32 s45, s45, 1
    s_cbranch_scc1 PDONE_2
    s_cbranch_vccz PDONE_2
    s_mov_b64 exec, vcc
    buffer_load_dwordx4 v[70:73], v29, s[36:39], s59 offen sc1
    s_waitcnt vmcnt(0)
    s_branch POLL_1
PDONE_2:
    s_mov_b64 exec, -1
    s_waitcnt lgkmcnt(8)
    v_mfma_f32_32x32x16_bf16 v[76:91], v[34:37], v[16:19], v[76:91]
    ds_read_b128 v[66:69], v24 offset:0
    ds_read_b64_tr_b16 v[172:173], v30 offset:20480
    ds_read_b64_tr_b16 v[174:175], v30 offset:21504
    v_mov_b32 v1, 0x2edbe6ff
    s_waitcnt lgkmcnt(9)
    v_mfma_f32_32x32x16_bf16 v[92:107], v[156:159], v[16:19], v[92:107]
    ds_read_b64_tr_b16 v[176:177], v31 offset:20480
    ds_read_b64_tr_b16 v[178:179], v31 offset:21504
    v_fmamk_f32 v192, v72, 0x3f800054, v1
    s_waitcnt lgkmcnt(9)
    v_mfma_f32_32x32x16_bf16 v[108:123], v[160:163], v[16:19], v[108:123]
    ds_read_b64_tr_b16 v[180:181], v32 offset:20480
    ds_read_b64_tr_b16 v[182:183], v32 offset:21504
    v_sqrt_f32 v192, v192
    s_waitcnt lgkmcnt(9)
    v_mfma_f32_32x32x16_bf16 v[124:139], v[164:167], v[16:19], v[124:139]
    ds_read_b64_tr_b16 v[184:185], v33 offset:20480
    ds_read_b64_tr_b16 v[186:187], v33 offset:21504
    v_and_b32 v1, 0xffff0000, v70
    s_waitcnt lgkmcnt(9)
    v_mfma_f32_32x32x16_bf16 v[140:155], v[168:171], v[16:19], v[140:155]
    v_sub_f32 v2, v70, v1
    s_waitcnt lgkmcnt(8)
    v_mfma_f32_32x32x16_bf16 v[76:91], v[38:41], v[66:69], v[76:91]
    ds_read_b128 v[16:19], v25 offset:0
    ds_read_b64_tr_b16 v[156:157], v30 offset:24576
    ds_read_b64_tr_b16 v[158:159], v30 offset:25600
    v_cvt_pk_bf16_f32 v188, -v1, -v1
    s_waitcnt lgkmcnt(9)
    v_mfma_f32_32x32x16_bf16 v[92:107], v[172:175], v[66:69], v[92:107]
    ds_read_b64_tr_b16 v[160:161], v31 offset:24576
    ds_read_b64_tr_b16 v[162:163], v31 offset:25600
    v_cvt_pk_bf16_f32 v189, -v2, -v2
    s_waitcnt lgkmcnt(9)
    v_mfma_f32_32x32x16_bf16 v[108:123], v[176:179], v[66:69], v[108:123]
    ds_read_b64_tr_b16 v[164:165], v32 offset:24576
    ds_read_b64_tr_b16 v[166:167], v32 offset:25600
    v_and_b32 v1, 0xffff0000, v192
    s_waitcnt lgkmcnt(9)
    v_mfma_f32_32x32x16_bf16 v[124:139], v[180:183], v[66:69], v[124:139]
    ds_read_b64_tr_b16 v[168:169], v33 offset:24576
    ds_read_b64_tr_b16 v[170:171], v33 offset:25600
    v_sub_f32 v2, v192, v1
    s_waitcnt lgkmcnt(9)
    v_mfma_f32_32x32x16_bf16 v[140:155], v[184:187], v[66:69], v[140:155]
    v_cvt_pk_bf16_f32 v190, v1, v2
    s_waitcnt lgkmcnt(8)
    v_mfma_f32_32x32x16_bf16 v[76:91], v[42:45], v[16:19], v[76:91]
    ds_read_b128 v[66:69], v26 offset:0
    ds_read_b64_tr_b16 v[172:173], v30 offset:28672
    ds_read_b64_tr_b16 v[174:175], v30 offset:29696
    v_mov_b32 v191, 0
    s_waitcnt lgkmcnt(9)
    v_mfma_f32_32x32x16_bf16 v[92:107], v[156:159], v[16:19], v[92:107]
    ds_read_b64_tr_b16 v[176:177], v31 offset:28672
    ds_read_b64_tr_b16 v[178:179], v31 offset:29696
    v_subrev_u32 v1, 1, v6
    s_waitcnt lgkmcnt(9)
    v_mfma_f32_32x32x16_bf16 v[108:123], v[160:163], v[16:19], v[108:123]
    ds_read_b64_tr_b16 v[180:181], v32 offset:28672
    ds_read_b64_tr_b16 v[182:183], v32 offset:29696
    v_and_b32 v188, v188, v1
    s_waitcnt lgkmcnt(9)
    v_mfma_f32_32x32x16_bf16 v[124:139], v[164:167], v[16:19], v[124:139]
    ds_read_b64_tr_b16 v[184:185], v33 offset:28672
    ds_read_b64_tr_b16 v[186:187], v33 offset:29696
    v_and_b32 v189, v189, v1
    s_waitcnt lgkmcnt(9)
    v_mfma_f32_32x32x16_bf16 v[140:155], v[168:171], v[16:19], v[140:155]
    v_and_b32 v190, v190, v1
    s_barrier
    s_waitcnt lgkmcnt(8)
    v_mfma_f32_32x32x16_bf16 v[76:91], v[46:49], v[66:69], v[76:91]
    ds_read_b128 v[16:19], v23 offset:32768
    ds_read_b64_tr_b16 v[156:157], v30 offset:49152
    ds_read_b64_tr_b16 v[158:159], v30 offset:50176
    v_rcp_f32 v1, v192
    s_waitcnt lgkmcnt(9)
    v_mfma_f32_32x32x16_bf16 v[92:107], v[172:175], v[66:69], v[92:107]
    ds_read_b64_tr_b16 v[160:161], v31 offset:49152
    ds_read_b64_tr_b16 v[162:163], v31 offset:50176
    v_mov_b32 v193, v192
    s_waitcnt lgkmcnt(9)
    v_mfma_f32_32x32x16_bf16 v[108:123], v[176:179], v[66:69], v[108:123]
    ds_read_b64_tr_b16 v[164:165], v32 offset:49152
    ds_read_b64_tr_b16 v[166:167], v32 offset:50176
    v_mul_f32 v21, 0xc0135761, v1
    s_waitcnt lgkmcnt(9)
    v_mfma_f32_32x32x16_bf16 v[124:139], v[180:183], v[66:69], v[124:139]
    ds_read_b64_tr_b16 v[168:169], v33 offset:49152
    ds_read_b64_tr_b16 v[170:171], v33 offset:50176
    v_mul_f32 v2, v1, v1
    s_waitcnt lgkmcnt(9)
    v_mfma_f32_32x32x16_bf16 v[140:155], v[184:187], v[66:69], v[140:155]
    v_mul_f32 v2, v2, v1
    s_waitcnt lgkmcnt(8)
    v_mfma_f32_32x32x16_bf16 v[76:91], v[50:53], v[16:19], v[76:91]
    ds_read_b128 v[66:69], v24 offset:32768
    ds_read_b64_tr_b16 v[172:173], v30 offset:53248
    ds_read_b64_tr_b16 v[174:175], v30 offset:54272
    v_mul_f32 v20, 0xbdd2d3e8, v2
    s_waitcnt lgkmcnt(9)
    v_mfma_f32_32x32x16_bf16 v[92:107], v[156:159], v[16:19], v[92:107]
    ds_read_b64_tr_b16 v[176:177], v31 offset:53248
    ds_read_b64_tr_b16 v[178:179], v31 offset:54272
    v_add_f32 v74, 0x3727c5ac, v72
    s_waitcnt lgkmcnt(9)
    v_mfma_f32_32x32x16_bf16 v[108:123], v[160:163], v[16:19], v[108:123]
    ds_read_b64_tr_b16 v[180:181], v32 offset:53248
    ds_read_b64_tr_b16 v[182:183], v32 offset:54272
    v_rsq_f32 v74, v74
    s_waitcnt lgkmcnt(9)
    v_mfma_f32_32x32x16_bf16 v[124:139], v[164:167], v[16:19], v[124:139]
    ds_read_b64_tr_b16 v[184:185], v33 offset:53248
    ds_read_b64_tr_b16 v[186:187], v33 offset:54272
    s_waitcnt lgkmcnt(9)
    v_mfma_f32_32x32x16_bf16 v[140:155], v[168:171], v[16:19], v[140:155]
    s_waitcnt lgkmcnt(8)
    v_mfma_f32_32x32x16_bf16 v[76:91], v[54:57], v[66:69], v[76:91]
    ds_read_b128 v[16:19], v25 offset:32768
    ds_read_b64_tr_b16 v[156:157], v30 offset:57344
    ds_read_b64_tr_b16 v[158:159], v30 offset:58368
    s_waitcnt lgkmcnt(9)
    v_mfma_f32_32x32x16_bf16 v[92:107], v[172:175], v[66:69], v[92:107]
    ds_read_b64_tr_b16 v[160:161], v31 offset:57344
    ds_read_b64_tr_b16 v[162:163], v31 offset:58368
    s_waitcnt lgkmcnt(9)
    v_mfma_f32_32x32x16_bf16 v[108:123], v[176:179], v[66:69], v[108:123]
    ds_read_b64_tr_b16 v[164:165], v32 offset:57344
    ds_read_b64_tr_b16 v[166:167], v32 offset:58368
    s_waitcnt lgkmcnt(9)
    v_mfma_f32_32x32x16_bf16 v[124:139], v[180:183], v[66:69], v[124:139]
    ds_read_b64_tr_b16 v[168:169], v33 offset:57344
    ds_read_b64_tr_b16 v[170:171], v33 offset:58368
    s_waitcnt lgkmcnt(9)
    v_mfma_f32_32x32x16_bf16 v[140:155], v[184:187], v[66:69], v[140:155]
    s_waitcnt lgkmcnt(8)
    v_mfma_f32_32x32x16_bf16 v[76:91], v[58:61], v[16:19], v[76:91]
    ds_read_b128 v[66:69], v26 offset:32768
    ds_read_b64_tr_b16 v[172:173], v30 offset:61440
    ds_read_b64_tr_b16 v[174:175], v30 offset:62464
    s_waitcnt lgkmcnt(9)
    v_mfma_f32_32x32x16_bf16 v[92:107], v[156:159], v[16:19], v[92:107]
    ds_read_b64_tr_b16 v[176:177], v31 offset:61440
    ds_read_b64_tr_b16 v[178:179], v31 offset:62464
    s_waitcnt lgkmcnt(9)
    v_mfma_f32_32x32x16_bf16 v[108:123], v[160:163], v[16:19], v[108:123]
    ds_read_b64_tr_b16 v[180:181], v32 offset:61440
    ds_read_b64_tr_b16 v[182:183], v32 offset:62464
    s_waitcnt lgkmcnt(9)
    v_mfma_f32_32x32x16_bf16 v[124:139], v[164:167], v[16:19], v[124:139]
    ds_read_b64_tr_b16 v[184:185], v33 offset:61440
    ds_read_b64_tr_b16 v[186:187], v33 offset:62464
    s_waitcnt lgkmcnt(9)
    v_mfma_f32_32x32x16_bf16 v[140:155], v[168:171], v[16:19], v[140:155]
    s_barrier
    s_waitcnt lgkmcnt(8)
    v_mfma_f32_32x32x16_bf16 v[76:91], v[62:65], v[66:69], v[76:91]
    ds_read_b128 v[156:159], v11 offset:0
    s_waitcnt lgkmcnt(7)
    v_mfma_f32_32x32x16_bf16 v[92:107], v[172:175], v[66:69], v[92:107]
    ds_read_b128 v[160:163], v11 offset:512
    s_waitcnt lgkmcnt(6)
    v_mfma_f32_32x32x16_bf16 v[108:123], v[176:179], v[66:69], v[108:123]
    ds_read_b128 v[164:167], v11 offset:1024
    s_waitcnt lgkmcnt(5)
    v_mfma_f32_32x32x16_bf16 v[124:139], v[180:183], v[66:69], v[124:139]
    ds_read_b128 v[168:171], v11 offset:1536
    s_nop 1
    v_mul_f32 v76, v76, v74
    v_mul_f32 v77, v77, v74
    v_cvt_pk_bf16_f32 v13, v76, v77
    ds_write_b32 v12, v13 offset:0
    v_mul_f32 v78, v78, v74
    v_mul_f32 v79, v79, v74
    s_waitcnt lgkmcnt(5)
    v_mfma_f32_32x32x16_bf16 v[140:155], v[184:187], v[66:69], v[140:155]
    v_cvt_pk_bf16_f32 v14, v78, v79
    ds_write_b32 v12, v14 offset:128
    v_mul_f32 v80, v80, v74
    v_mul_f32 v81, v81, v74
    v_cvt_pk_bf16_f32 v13, v80, v81
    ds_write_b32 v12, v13 offset:256
    s_waitcnt lgkmcnt(6)
    v_mfma_f32_32x32x16_bf16 v[92:107], v[156:159], v[188:191], v[92:107]
    v_mul_f32 v82, v82, v74
    v_mul_f32 v83, v83, v74
    v_cvt_pk_bf16_f32 v14, v82, v83
    ds_write_b32 v12, v14 offset:384
    v_mul_f32 v84, v84, v74
    v_mul_f32 v85, v85, v74
    s_waitcnt lgkmcnt(6)
    v_mfma_f32_32x32x16_bf16 v[108:123], v[160:163], v[188:191], v[108:123]
    v_cvt_pk_bf16_f32 v13, v84, v85
    ds_write_b32 v12, v13 offset:1024
    v_mul_f32 v86, v86, v74
    v_mul_f32 v87, v87, v74
    v_cvt_pk_bf16_f32 v14, v86, v87
    ds_write_b32 v12, v14 offset:1152
    s_waitcnt lgkmcnt(7)
    v_mfma_f32_32x32x16_bf16 v[124:139], v[164:167], v[188:191], v[124:139]
    v_mul_f32 v88, v88, v74
    v_mul_f32 v89, v89, v74
    v_cvt_pk_bf16_f32 v13, v88, v89
    ds_write_b32 v12, v13 offset:1280
    v_mul_f32 v90, v90, v74
    v_mul_f32 v91, v91, v74
    s_waitcnt lgkmcnt(7)
    v_mfma_f32_32x32x16_bf16 v[140:155], v[168:171], v[188:191], v[140:155]
    v_cvt_pk_bf16_f32 v14, v90, v91
    ds_write_b32 v12, v14 offset:1408
    s_waitcnt lgkmcnt(0)
    s_barrier
    s_lshl_b32 s48, s42, 2
    s_add_u32 s48, s48, s40
    s_lshl_b32 s48, s48, 2
    s_add_u32 s48, s48, s3
    s_lshl_b32 s61, s48, 9
    s_add_u32 s61, s61, 22740992
    s_mul_i32 s48, s48, 28672
    s_add_u32 s60, s48, 6750208
    s_lshl_b32 s48, s41, 13
    s_add_u32 s48, s48, s60
    s_add_u32 s49, s48, 4096
    v_xor_b32 v30, 0x30000, v30
    v_xor_b32 v31, 0x30000, v31
    v_xor_b32 v32, 0x30000, v32
    v_xor_b32 v33, 0x30000, v33
    v_pk_mul_f32 v[66:67], v[92:93], v[92:93]
    v_pk_mul_f32 v[68:69], v[94:95], v[94:95]
    v_pk_mul_f32 v[70:71], v[96:97], v[96:97]
    v_pk_mul_f32 v[72:73], v[98:99], v[98:99]
    v_pk_fma_f32 v[66:67], v[66:67], v[20:21], v[20:21] op_sel:[0,0,1] op_sel_hi:[1,0,1]
    v_pk_fma_f32 v[68:69], v[68:69], v[20:21], v[20:21] op_sel:[0,0,1] op_sel_hi:[1,0,1]
    v_pk_fma_f32 v[70:71], v[70:71], v[20:21], v[20:21] op_sel:[0,0,1] op_sel_hi:[1,0,1]
    v_pk_fma_f32 v[72:73], v[72:73], v[20:21], v[20:21] op_sel:[0,0,1] op_sel_hi:[1,0,1]
    v_pk_mul_f32 v[66:67], v[66:67], v[92:93]
    v_pk_mul_f32 v[68:69], v[68:69], v[94:95]
    v_pk_mul_f32 v[70:71], v[70:71], v[96:97]
    v_pk_mul_f32 v[72:73], v[72:73], v[98:99]
    v_exp_f32 v66, v66
    v_exp_f32 v67, v67
    v_exp_f32 v68, v68
    v_exp_f32 v69, v69
    v_exp_f32 v70, v70
    v_exp_f32 v71, v71
    v_exp_f32 v72, v72
    v_exp_f32 v73, v73
    v_pk_fma_f32 v[66:67], v[66:67], v[192:193], v[192:193]
    v_pk_fma_f32 v[68:69], v[68:69], v[192:193], v[192:193]
    v_pk_fma_f32 v[70:71], v[70:71], v[192:193], v[192:193]
    v_pk_fma_f32 v[72:73], v[72:73], v[192:193], v[192:193]
    v_rcp_f32 v66, v66
    v_rcp_f32 v67, v67
    v_rcp_f32 v68, v68
    v_rcp_f32 v69, v69
    v_rcp_f32 v70, v70
    v_rcp_f32 v71, v71
    v_rcp_f32 v72, v72
    v_rcp_f32 v73, v73
    v_pk_mul_f32 v[66:67], v[66:67], v[92:93]
    v_pk_mul_f32 v[68:69], v[68:69], v[94:95]
    v_pk_mul_f32 v[70:71], v[70:71], v[96:97]
    v_pk_mul_f32 v[72:73], v[72:73], v[98:99]
    v_cvt_pk_bf16_f32 v34, v66, v67
    v_cvt_pk_bf16_f32 v35, v68, v69
    v_cvt_pk_bf16_f32 v36, v70, v71
    v_cvt_pk_bf16_f32 v37, v72, v73
    buffer_store_dwordx4 v[34:37], v9, s[36:39], s48 offen offset:0 sc1
    v_pk_mul_f32 v[66:67], v[100:101], v[100:101]
    v_pk_mul_f32 v[68:69], v[102:103], v[102:103]
    v_pk_mul_f32 v[70:71], v[104:105], v[104:105]
    v_pk_mul_f32 v[72:73], v[106:107], v[106:107]
    v_pk_fma_f32 v[66:67], v[66:67], v[20:21], v[20:21] op_sel:[0,0,1] op_sel_hi:[1,0,1]
    v_pk_fma_f32 v[68:69], v[68:69], v[20:21], v[20:21] op_sel:[0,0,1] op_sel_hi:[1,0,1]
    v_pk_fma_f32 v[70:71], v[70:71], v[20:21], v[20:21] op_sel:[0,0,1] op_sel_hi:[1,0,1]
    v_pk_fma_f32 v[72:73], v[72:73], v[20:21], v[20:21] op_sel:[0,0,1] op_sel_hi:[1,0,1]
    v_pk_mul_f32 v[66:67], v[66:67], v[100:101]
    v_pk_mul_f32 v[68:69], v[68:69], v[102:103]
    v_pk_mul_f32 v[70:71], v[70:71], v[104:105]
    v_pk_mul_f32 v[72:73], v[72:73], v[106:107]
    v_exp_f32 v66, v66
    v_exp_f32 v67, v67
    v_exp_f32 v68, v68
    v_exp_f32 v69, v69
    v_exp_f32 v70, v70
    v_exp_f32 v71, v71
    v_exp_f32 v72, v72
    v_exp_f32 v73, v73
    v_pk_fma_f32 v[66:67], v[66:67], v[192:193], v[192:193]
    v_pk_fma_f32 v[68:69], v[68:69], v[192:193], v[192:193]
    v_pk_fma_f32 v[70:71], v[70:71], v[192:193], v[192:193]
    v_pk_fma_f32 v[72:73], v[72:73], v[192:193], v[192:193]
    v_rcp_f32 v66, v66
    v_rcp_f32 v67, v67
    v_rcp_f32 v68, v68
    v_rcp_f32 v69, v69
    v_rcp_f32 v70, v70
    v_rcp_f32 v71, v71
    v_rcp_f32 v72, v72
    v_rcp_f32 v73, v73
    v_pk_mul_f32 v[66:67], v[66:67], v[100:101]
    v_pk_mul_f32 v[68:69], v[68:69], v[102:103]
    v_pk_mul_f32 v[70:71], v[70:71], v[104:105]
    v_pk_mul_f32 v[72:73], v[72:73], v[106:107]
    v_cvt_pk_bf16_f32 v38, v66, v67
    v_cvt_pk_bf16_f32 v39, v68, v69
    v_cvt_pk_bf16_f32 v40, v70, v71
    v_cvt_pk_bf16_f32 v41, v72, v73
    buffer_store_dwordx4 v[38:41], v9, s[36:39], s48 offen offset:1024 sc1
    v_pk_mul_f32 v[66:67], v[108:109], v[108:109]
    v_pk_mul_f32 v[68:69], v[110:111], v[110:111]
    v_pk_mul_f32 v[70:71], v[112:113], v[112:113]
    v_pk_mul_f32 v[72:73], v[114:115], v[114:115]
    v_pk_fma_f32 v[66:67], v[66:67], v[20:21], v[20:21] op_sel:[0,0,1] op_sel_hi:[1,0,1]
    v_pk_fma_f32 v[68:69], v[68:69], v[20:21], v[20:21] op_sel:[0,0,1] op_sel_hi:[1,0,1]
    v_pk_fma_f32 v[70:71], v[70:71], v[20:21], v[20:21] op_sel:[0,0,1] op_sel_hi:[1,0,1]
    v_pk_fma_f32 v[72:73], v[72:73], v[20:21], v[20:21] op_sel:[0,0,1] op_sel_hi:[1,0,1]
    v_pk_mul_f32 v[66:67], v[66:67], v[108:109]
    v_pk_mul_f32 v[68:69], v[68:69], v[110:111]
    v_pk_mul_f32 v[70:71], v[70:71], v[112:113]
    v_pk_mul_f32 v[72:73], v[72:73], v[114:115]
    v_exp_f32 v66, v66
    v_exp_f32 v67, v67
    v_exp_f32 v68, v68
    v_exp_f32 v69, v69
    v_exp_f32 v70, v70
    v_exp_f32 v71, v71
    v_exp_f32 v72, v72
    v_exp_f32 v73, v73
    v_pk_fma_f32 v[66:67], v[66:67], v[192:193], v[192:193]
    v_pk_fma_f32 v[68:69], v[68:69], v[192:193], v[192:193]
    v_pk_fma_f32 v[70:71], v[70:71], v[192:193], v[192:193]
    v_pk_fma_f32 v[72:73], v[72:73], v[192:193], v[192:193]
    v_rcp_f32 v66, v66
    v_rcp_f32 v67, v67
    v_rcp_f32 v68, v68
    v_rcp_f32 v69, v69
    v_rcp_f32 v70, v70
    v_rcp_f32 v71, v71
    v_rcp_f32 v72, v72
    v_rcp_f32 v73, v73
    v_pk_mul_f32 v[66:67], v[66:67], v[108:109]
    v_pk_mul_f32 v[68:69], v[68:69], v[110:111]
    v_pk_mul_f32 v[70:71], v[70:71], v[112:113]
    v_pk_mul_f32 v[72:73], v[72:73], v[114:115]
    v_cvt_pk_bf16_f32 v42, v66, v67
    v_cvt_pk_bf16_f32 v43, v68, v69
    v_cvt_pk_bf16_f32 v44, v70, v71
    v_cvt_pk_bf16_f32 v45, v72, v73
    buffer_store_dwordx4 v[42:45], v9, s[36:39], s48 offen offset:2048 sc1
    v_pk_mul_f32 v[66:67], v[116:117], v[116:117]
    v_pk_mul_f32 v[68:69], v[118:119], v[118:119]
    v_pk_mul_f32 v[70:71], v[120:121], v[120:121]
    v_pk_mul_f32 v[72:73], v[122:123], v[122:123]
    v_pk_fma_f32 v[66:67], v[66:67], v[20:21], v[20:21] op_sel:[0,0,1] op_sel_hi:[1,0,1]
    v_pk_fma_f32 v[68:69], v[68:69], v[20:21], v[20:21] op_sel:[0,0,1] op_sel_hi:[1,0,1]
    v_pk_fma_f32 v[70:71], v[70:71], v[20:21], v[20:21] op_sel:[0,0,1] op_sel_hi:[1,0,1]
    v_pk_fma_f32 v[72:73], v[72:73], v[20:21], v[20:21] op_sel:[0,0,1] op_sel_hi:[1,0,1]
    v_pk_mul_f32 v[66:67], v[66:67], v[116:117]
    v_pk_mul_f32 v[68:69], v[68:69], v[118:119]
    v_pk_mul_f32 v[70:71], v[70:71], v[120:121]
    v_pk_mul_f32 v[72:73], v[72:73], v[122:123]
    v_exp_f32 v66, v66
    v_exp_f32 v67, v67
    v_exp_f32 v68, v68
    v_exp_f32 v69, v69
    v_exp_f32 v70, v70
    v_exp_f32 v71, v71
    v_exp_f32 v72, v72
    v_exp_f32 v73, v73
    v_pk_fma_f32 v[66:67], v[66:67], v[192:193], v[192:193]
    v_pk_fma_f32 v[68:69], v[68:69], v[192:193], v[192:193]
    v_pk_fma_f32 v[70:71], v[70:71], v[192:193], v[192:193]
    v_pk_fma_f32 v[72:73], v[72:73], v[192:193], v[192:193]
    v_rcp_f32 v66, v66
    v_rcp_f32 v67, v67
    v_rcp_f32 v68, v68
    v_rcp_f32 v69, v69
    v_rcp_f32 v70, v70
    v_rcp_f32 v71, v71
    v_rcp_f32 v72, v72
    v_rcp_f32 v73, v73
    v_pk_mul_f32 v[66:67], v[66:67], v[116:117]
    v_pk_mul_f32 v[68:69], v[68:69], v[118:119]
    v_pk_mul_f32 v[70:71], v[70:71], v[120:121]
    v_pk_mul_f32 v[72:73], v[72:73], v[122:123]
    v_cvt_pk_bf16_f32 v46, v66, v67
    v_cvt_pk_bf16_f32 v47, v68, v69
    v_cvt_pk_bf16_f32 v48, v70, v71
    v_cvt_pk_bf16_f32 v49, v72, v73
    buffer_store_dwordx4 v[46:49], v9, s[36:39], s48 offen offset:3072 sc1
    s_cmp_eq_u32 s41, 3
    s_cbranch_scc1 LIGHT_3
    v_pk_mul_f32 v[66:67], v[124:125], v[124:125]
    v_pk_mul_f32 v[68:69], v[126:127], v[126:127]
    v_pk_mul_f32 v[70:71], v[128:129], v[128:129]
    v_pk_mul_f32 v[72:73], v[130:131], v[130:131]
    v_pk_fma_f32 v[66:67], v[66:67], v[20:21], v[20:21] op_sel:[0,0,1] op_sel_hi:[1,0,1]
    v_pk_fma_f32 v[68:69], v[68:69], v[20:21], v[20:21] op_sel:[0,0,1] op_sel_hi:[1,0,1]
    v_pk_fma_f32 v[70:71], v[70:71], v[20:21], v[20:21] op_sel:[0,0,1] op_sel_hi:[1,0,1]
    v_pk_fma_f32 v[72:73], v[72:73], v[20:21], v[20:21] op_sel:[0,0,1] op_sel_hi:[1,0,1]
    v_pk_mul_f32 v[66:67], v[66:67], v[124:125]
    v_pk_mul_f32 v[68:69], v[68:69], v[126:127]
    v_pk_mul_f32 v[70:71], v[70:71], v[128:129]
    v_pk_mul_f32 v[72:73], v[72:73], v[130:131]
    v_exp_f32 v66, v66
    v_exp_f32 v67, v67
    v_exp_f32 v68, v68
    v_exp_f32 v69, v69
    v_exp_f32 v70, v70
    v_exp_f32 v71, v71
    v_exp_f32 v72, v72
    v_exp_f32 v73, v73
    v_pk_fma_f32 v[66:67], v[66:67], v[192:193], v[192:193]
    v_pk_fma_f32 v[68:69], v[68:69], v[192:193], v[192:193]
    v_pk_fma_f32 v[70:71], v[70:71], v[192:193], v[192:193]
    v_pk_fma_f32 v[72:73], v[72:73], v[192:193], v[192:193]
    v_rcp_f32 v66, v66
    v_rcp_f32 v67, v67
    v_rcp_f32 v68, v68
    v_rcp_f32 v69, v69
    v_rcp_f32 v70, v70
    v_rcp_f32 v71, v71
    v_rcp_f32 v72, v72
    v_rcp_f32 v73, v73
    v_pk_mul_f32 v[66:67], v[66:67], v[124:125]
    v_pk_mul_f32 v[68:69], v[68:69], v[126:127]
    v_pk_mul_f32 v[70:71], v[70:71], v[128:129]
    v_pk_mul_f32 v[72:73], v[72:73], v[130:131]
    v_cvt_pk_bf16_f32 v50, v66, v67
    v_cvt_pk_bf16_f32 v51, v68, v69
    v_cvt_pk_bf16_f32 v52, v70, v71
    v_cvt_pk_bf16_f32 v53, v72, v73
    buffer_store_dwordx4 v[50:53], v9, s[36:39], s49 offen offset:0 sc1
    v_pk_mul_f32 v[66:67], v[132:133], v[132:133]
    v_pk_mul_f32 v[68:69], v[134:135], v[134:135]
    v_pk_mul_f32 v[70:71], v[136:137], v[136:137]
    v_pk_mul_f32 v[72:73], v[138:139], v[138:139]
    v_pk_fma_f32 v[66:67], v[66:67], v[20:21], v[20:21] op_sel:[0,0,1] op_sel_hi:[1,0,1]
    v_pk_fma_f32 v[68:69], v[68:69], v[20:21], v[20:21] op_sel:[0,0,1] op_sel_hi:[1,0,1]
    v_pk_fma_f32 v[70:71], v[70:71], v[20:21], v[20:21] op_sel:[0,0,1] op_sel_hi:[1,0,1]
    v_pk_fma_f32 v[72:73], v[72:73], v[20:21], v[20:21] op_sel:[0,0,1] op_sel_hi:[1,0,1]
    v_pk_mul_f32 v[66:67], v[66:67], v[132:133]
    v_pk_mul_f32 v[68:69], v[68:69], v[134:135]
    v_pk_mul_f32 v[70:71], v[70:71], v[136:137]
    v_pk_mul_f32 v[72:73], v[72:73], v[138:139]
    v_exp_f32 v66, v66
    v_exp_f32 v67, v67
    v_exp_f32 v68, v68
    v_exp_f32 v69, v69
    v_exp_f32 v70, v70
    v_exp_f32 v71, v71
    v_exp_f32 v72, v72
    v_exp_f32 v73, v73
    v_pk_fma_f32 v[66:67], v[66:67], v[192:193], v[192:193]
    v_pk_fma_f32 v[68:69], v[68:69], v[192:193], v[192:193]
    v_pk_fma_f32 v[70:71], v[70:71], v[192:193], v[192:193]
    v_pk_fma_f32 v[72:73], v[72:73], v[192:193], v[192:193]
    v_rcp_f32 v66, v66
    v_rcp_f32 v67, v67
    v_rcp_f32 v68, v68
    v_rcp_f32 v69, v69
    v_rcp_f32 v70, v70
    v_rcp_f32 v71, v71
    v_rcp_f32 v72, v72
    v_rcp_f32 v73, v73
    v_pk_mul_f32 v[66:67], v[66:67], v[132:133]
    v_pk_mul_f32 v[68:69], v[68:69], v[134:135]
    v_pk_mul_f32 v[70:71], v[70:71], v[136:137]
    v_pk_mul_f32 v[72:73], v[72:73], v[138:139]
    v_cvt_pk_bf16_f32 v54, v66, v67
    v_cvt_pk_bf16_f32 v55, v68, v69
    v_cvt_pk_bf16_f32 v56, v70, v71
    v_cvt_pk_bf16_f32 v57, v72, v73
    buffer_store_dwordx4 v[54:57], v9, s[36:39], s49 offen offset:1024 sc1
    v_pk_mul_f32 v[66:67], v[140:141], v[140:141]
    v_pk_mul_f32 v[68:69], v[142:143], v[142:143]
    v_pk_mul_f32 v[70:71], v[144:145], v[144:145]
    v_pk_mul_f32 v[72:73], v[146:147], v[146:147]
    v_pk_fma_f32 v[66:67], v[66:67], v[20:21], v[20:21] op_sel:[0,0,1] op_sel_hi:[1,0,1]
    v_pk_fma_f32 v[68:69], v[68:69], v[20:21], v[20:21] op_sel:[0,0,1] op_sel_hi:[1,0,1]
    v_pk_fma_f32 v[70:71], v[70:71], v[20:21], v[20:21] op_sel:[0,0,1] op_sel_hi:[1,0,1]
    v_pk_fma_f32 v[72:73], v[72:73], v[20:21], v[20:21] op_sel:[0,0,1] op_sel_hi:[1,0,1]
    v_pk_mul_f32 v[66:67], v[66:67], v[140:141]
    v_pk_mul_f32 v[68:69], v[68:69], v[142:143]
    v_pk_mul_f32 v[70:71], v[70:71], v[144:145]
    v_pk_mul_f32 v[72:73], v[72:73], v[146:147]
    v_exp_f32 v66, v66
    v_exp_f32 v67, v67
    v_exp_f32 v68, v68
    v_exp_f32 v69, v69
    v_exp_f32 v70, v70
    v_exp_f32 v71, v71
    v_exp_f32 v72, v72
    v_exp_f32 v73, v73
    v_pk_fma_f32 v[66:67], v[66:67], v[192:193], v[192:193]
    v_pk_fma_f32 v[68:69], v[68:69], v[192:193], v[192:193]
    v_pk_fma_f32 v[70:71], v[70:71], v[192:193], v[192:193]
    v_pk_fma_f32 v[72:73], v[72:73], v[192:193], v[192:193]
    v_rcp_f32 v66, v66
    v_rcp_f32 v67, v67
    v_rcp_f32 v68, v68
    v_rcp_f32 v69, v69
    v_rcp_f32 v70, v70
    v_rcp_f32 v71, v71
    v_rcp_f32 v72, v72
    v_rcp_f32 v73, v73
    v_pk_mul_f32 v[66:67], v[66:67], v[140:141]
    v_pk_mul_f32 v[68:69], v[68:69], v[142:143]
    v_pk_mul_f32 v[70:71], v[70:71], v[144:145]
    v_pk_mul_f32 v[72:73], v[72:73], v[146:147]
    v_cvt_pk_bf16_f32 v58, v66, v67
    v_cvt_pk_bf16_f32 v59, v68, v69
    v_cvt_pk_bf16_f32 v60, v70, v71
    v_cvt_pk_bf16_f32 v61, v72, v73
    buffer_store_dwordx4 v[58:61], v9, s[36:39], s49 offen offset:2048 sc1
    v_pk_mul_f32 v[66:67], v[148:149], v[148:149]
    v_pk_mul_f32 v[68:69], v[150:151], v[150:151]
    v_pk_mul_f32 v[70:71], v[152:153], v[152:153]
    v_pk_mul_f32 v[72:73], v[154:155], v[154:155]
    v_pk_fma_f32 v[66:67], v[66:67], v[20:21], v[20:21] op_sel:[0,0,1] op_sel_hi:[1,0,1]
    v_pk_fma_f32 v[68:69], v[68:69], v[20:21], v[20:21] op_sel:[0,0,1] op_sel_hi:[1,0,1]
    v_pk_fma_f32 v[70:71], v[70:71], v[20:21], v[20:21] op_sel:[0,0,1] op_sel_hi:[1,0,1]
    v_pk_fma_f32 v[72:73], v[72:73], v[20:21], v[20:21] op_sel:[0,0,1] op_sel_hi:[1,0,1]
    v_pk_mul_f32 v[66:67], v[66:67], v[148:149]
    v_pk_mul_f32 v[68:69], v[68:69], v[150:151]
    v_pk_mul_f32 v[70:71], v[70:71], v[152:153]
    v_pk_mul_f32 v[72:73], v[72:73], v[154:155]
    v_exp_f32 v66, v66
    v_exp_f32 v67, v67
    v_exp_f32 v68, v68
    v_exp_f32 v69, v69
    v_exp_f32 v70, v70
    v_exp_f32 v71, v71
    v_exp_f32 v72, v72
    v_exp_f32 v73, v73
    v_pk_fma_f32 v[66:67], v[66:67], v[192:193], v[192:193]
    v_pk_fma_f32 v[68:69], v[68:69], v[192:193], v[192:193]
    v_pk_fma_f32 v[70:71], v[70:71], v[192:193], v[192:193]
    v_pk_fma_f32 v[72:73], v[72:73], v[192:193], v[192:193]
    v_rcp_f32 v66, v66
    v_rcp_f32 v67, v67
    v_rcp_f32 v68, v68
    v_rcp_f32 v69, v69
    v_rcp_f32 v70, v70
    v_rcp_f32 v71, v71
    v_rcp_f32 v72, v72
    v_rcp_f32 v73, v73
    v_pk_mul_f32 v[66:67], v[66:67], v[148:149]
    v_pk_mul_f32 v[68:69], v[68:69], v[150:151]
    v_pk_mul_f32 v[70:71], v[70:71], v[152:153]
    v_pk_mul_f32 v[72:73], v[72:73], v[154:155]
    v_cvt_pk_bf16_f32 v62, v66, v67
    v_cvt_pk_bf16_f32 v63, v68, v69
    v_cvt_pk_bf16_f32 v64, v70, v71
    v_cvt_pk_bf16_f32 v65, v72, v73
    buffer_store_dwordx4 v[62:65], v9, s[36:39], s49 offen offset:3072 sc1
LIGHT_3:
    s_mov_b32 s45, 1048576
LW_4:
    ds_read_b128 v[16:19], v28 offset:0
    s_waitcnt lgkmcnt(0)
    v_min_u32 v16, v16, v17
    v_min3_u32 v16, v16, v18, v19
    v_cmp_eq_u32 vcc, 0, v16
    s_sub_u32 s45, s45, 1
    s_cbranch_scc1 LD_5
    s_cbranch_vccnz LW_4
LD_5:
    v_and_b32 v11, 3, v5
    v_lshlrev_b32 v11, 7, v11
    ds_read_b64_tr_b16 v[156:157], v30 offset:16384
    ds_read_b64_tr_b16 v[158:159], v30 offset:17408
    ds_read_b64_tr_b16 v[160:161], v31 offset:16384
    ds_read_b64_tr_b16 v[162:163], v31 offset:17408
    ds_read_b64_tr_b16 v[164:165], v32 offset:16384
    ds_read_b64_tr_b16 v[166:167], v32 offset:17408
    ds_read_b64_tr_b16 v[168:169], v33 offset:16384
    ds_read_b64_tr_b16 v[170:171], v33 offset:17408
    s_waitcnt lgkmcnt(6)
    v_mfma_f32_32x32x16_bf16 v[92:107], v[156:159], v[34:37], 0
    ds_read_b64_tr_b16 v[172:173], v30 offset:20480
    ds_read_b64_tr_b16 v[174:175], v30 offset:21504
    s_waitcnt lgkmcnt(6)
    v_mfma_f32_32x32x16_bf16 v[108:123], v[160:163], v[34:37], 0
    ds_read_b64_tr_b16 v[176:177], v31 offset:20480
    ds_read_b64_tr_b16 v[178:179], v31 offset:21504
    s_waitcnt lgkmcnt(6)
    v_mfma_f32_32x32x16_bf16 v[124:139], v[164:167], v[34:37], 0
    ds_read_b64_tr_b16 v[180:181], v32 offset:20480
    ds_read_b64_tr_b16 v[182:183], v32 offset:21504
    s_waitcnt lgkmcnt(6)
    v_mfma_f32_32x32x16_bf16 v[140:155], v[168:171], v[34:37], 0
    ds_read_b64_tr_b16 v[184:185], v33 offset:20480
    ds_read_b64_tr_b16 v[186:187], v33 offset:21504
    s_waitcnt lgkmcnt(6)
    v_mfma_f32_32x32x16_bf16 v[92:107], v[172:175], v[38:41], v[92:107]
    ds_read_b64_tr_b16 v[156:157], v30 offset:24576
    ds_read_b64_tr_b16 v[158:159], v30 offset:25600
    s_waitcnt lgkmcnt(6)
    v_mfma_f32_32x32x16_bf16 v[108:123], v[176:179], v[38:41], v[108:123]
    ds_read_b64_tr_b16 v[160:161], v31 offset:24576
    ds_read_b64_tr_b16 v[162:163], v31 offset:25600
    s_waitcnt lgkmcnt(6)
    v_mfma_f32_32x32x16_bf16 v[124:139], v[180:183], v[38:41], v[124:139]
    ds_read_b64_tr_b16 v[164:165], v32 offset:24576
    ds_read_b64_tr_b16 v[166:167], v32 offset:25600
    s_waitcnt lgkmcnt(6)
    v_mfma_f32_32x32x16_bf16 v[140:155], v[184:187], v[38:41], v[140:155]
    ds_read_b64_tr_b16 v[168:169], v33 offset:24576
    ds_read_b64_tr_b16 v[170:171], v33 offset:25600
    s_waitcnt lgkmcnt(6)
    v_mfma_f32_32x32x16_bf16 v[92:107], v[156:159], v[42:45], v[92:107]
    ds_read_b64_tr_b16 v[172:173], v30 offset:28672
    ds_read_b64_tr_b16 v[174:175], v30 offset:29696
    s_waitcnt lgkmcnt(6)
    v_mfma_f32_32x32x16_bf16 v[108:123], v[160:163], v[42:45], v[108:123]
    ds_read_b64_tr_b16 v[176:177], v31 offset:28672
    ds_read_b64_tr_b16 v[178:179], v31 offset:29696
    s_waitcnt lgkmcnt(6)
    v_mfma_f32_32x32x16_bf16 v[124:139], v[164:167], v[42:45], v[124:139]
    ds_read_b64_tr_b16 v[180:181], v32 offset:28672
    ds_read_b64_tr_b16 v[182:183], v32 offset:29696
    s_waitcnt lgkmcnt(6)
    v_mfma_f32_32x32x16_bf16 v[140:155], v[168:171], v[42:45], v[140:155]
    ds_read_b64_tr_b16 v[184:185], v33 offset:28672
    ds_read_b64_tr_b16 v[186:187], v33 offset:29696
    v_xor_b32 v30, 0x20000, v30
    v_xor_b32 v31, 0x20000, v31
    v_xor_b32 v32, 0x20000, v32
    v_xor_b32 v33, 0x20000, v33
    s_waitcnt lgkmcnt(6)
    v_mfma_f32_32x32x16_bf16 v[92:107], v[172:175], v[46:49], v[92:107]
    ds_read_b64_tr_b16 v[156:157], v30 offset:0
    ds_read_b64_tr_b16 v[158:159], v30 offset:1024
    s_waitcnt lgkmcnt(6)
    v_mfma_f32_32x32x16_bf16 v[108:123], v[176:179], v[46:49], v[108:123]
    ds_read_b64_tr_b16 v[160:161], v31 offset:0
    ds_read_b64_tr_b16 v[162:163], v31 offset:1024
    s_waitcnt lgkmcnt(6)
    v_mfma_f32_32x32x16_bf16 v[124:139], v[180:183], v[46:49], v[124:139]
    ds_read_b64_tr_b16 v[164:165], v32 offset:0
    ds_read_b64_tr_b16 v[166:167], v32 offset:1024
    s_waitcnt lgkmcnt(6)
    v_mfma_f32_32x32x16_bf16 v[140:155], v[184:187], v[46:49], v[140:155]
    ds_read_b64_tr_b16 v[168:169], v33 offset:0
    ds_read_b64_tr_b16 v[170:171], v33 offset:1024
    s_waitcnt vmcnt(0)
    s_lshl_b32 s48, s41, 7
    s_add_u32 s48, s48, s61
    buffer_store_dword v15, v10, s[36:39], s48 offen sc1
    s_cmp_lg_u32 s41, 3
    s_cbranch_scc1 HEAVY_6
    buffer_load_dword v12, v11, s[36:39], s61 offen sc1
    s_mov_b32 s45, 65536
    s_waitcnt vmcnt(0)
POLL_7:
    v_xor_b32 v1, s44, v12
    v_cmp_ne_u32 vcc, 0, v1
    s_sub_u32 s45, s45, 1
    s_cbranch_scc1 PDONE_8
    s_cbranch_vccz PDONE_8
    s_mov_b64 exec, vcc
    buffer_load_dword v12, v11, s[36:39], s61 offen sc1
    s_waitcnt vmcnt(0)
    s_branch POLL_7
PDONE_8:
    s_mov_b64 exec, -1
    s_bfe_u32 s50, s47, 196612
    s_lshl_b32 s50, s50, 12
    s_add_u32 s50, s50, s60
    buffer_load_dwordx4 v[50:53], v9, s[36:39], s50 offen offset:0 sc1
    buffer_load_dwordx4 v[54:57], v9, s[36:39], s50 offen offset:1024 sc1
    buffer_load_dwordx4 v[58:61], v9, s[36:39], s50 offen offset:2048 sc1
    buffer_load_dwordx4 v[62:65], v9, s[36:39], s50 offen offset:3072 sc1
    s_waitcnt vmcnt(0)
HEAVY_6:
    s_waitcnt lgkmcnt(6)
    v_mfma_f32_32x32x16_bf16 v[92:107], v[156:159], v[50:53], v[92:107]
    ds_read_b64_tr_b16 v[172:173], v30 offset:4096
    ds_read_b64_tr_b16 v[174:175], v30 offset:5120
    s_waitcnt lgkmcnt(6)
    v_mfma_f32_32x32x16_bf16 v[108:123], v[160:163], v[50:53], v[108:123]
    ds_read_b64_tr_b16 v[176:177], v31 offset:4096
    ds_read_b64_tr_b16 v[178:179], v31 offset:5120
    s_waitcnt lgkmcnt(6)
    v_mfma_f32_32x32x16_bf16 v[124:139], v[164:167], v[50:53], v[124:139]
    ds_read_b64_tr_b16 v[180:181], v32 offset:4096
    ds_read_b64_tr_b16 v[182:183], v32 offset:5120
    s_waitcnt lgkmcnt(6)
    v_mfma_f32_32x32x16_bf16 v[140:155], v[168:171], v[50:53], v[140:155]
    ds_read_b64_tr_b16 v[184:185], v33 offset:4096
    ds_read_b64_tr_b16 v[186:187], v33 offset:5120
    s_waitcnt lgkmcnt(6)
    v_mfma_f32_32x32x16_bf16 v[92:107], v[172:175], v[54:57], v[92:107]
    ds_read_b64_tr_b16 v[156:157], v30 offset:8192
    ds_read_b64_tr_b16 v[158:159], v30 offset:9216
    s_waitcnt lgkmcnt(6)
    v_mfma_f32_32x32x16_bf16 v[108:123], v[176:179], v[54:57], v[108:123]
    ds_read_b64_tr_b16 v[160:161], v31 offset:8192
    ds_read_b64_tr_b16 v[162:163], v31 offset:9216
    s_waitcnt lgkmcnt(6)
    v_mfma_f32_32x32x16_bf16 v[124:139], v[180:183], v[54:57], v[124:139]
    ds_read_b64_tr_b16 v[164:165], v32 offset:8192
    ds_read_b64_tr_b16 v[166:167], v32 offset:9216
    s_waitcnt lgkmcnt(6)
    v_mfma_f32_32x32x16_bf16 v[140:155], v[184:187], v[54:57], v[140:155]
    ds_read_b64_tr_b16 v[168:169], v33 offset:8192
    ds_read_b64_tr_b16 v[170:171], v33 offset:9216
    s_waitcnt lgkmcnt(6)
    v_mfma_f32_32x32x16_bf16 v[92:107], v[156:159], v[58:61], v[92:107]
    ds_read_b64_tr_b16 v[172:173], v30 offset:12288
    ds_read_b64_tr_b16 v[174:175], v30 offset:13312
    s_waitcnt lgkmcnt(6)
    v_mfma_f32_32x32x16_bf16 v[108:123], v[160:163], v[58:61], v[108:123]
    ds_read_b64_tr_b16 v[176:177], v31 offset:12288
    ds_read_b64_tr_b16 v[178:179], v31 offset:13312
    s_waitcnt lgkmcnt(6)
    v_mfma_f32_32x32x16_bf16 v[124:139], v[164:167], v[58:61], v[124:139]
    ds_read_b64_tr_b16 v[180:181], v32 offset:12288
    ds_read_b64_tr_b16 v[182:183], v32 offset:13312
    s_waitcnt lgkmcnt(6)
    v_mfma_f32_32x32x16_bf16 v[140:155], v[168:171], v[58:61], v[140:155]
    ds_read_b64_tr_b16 v[184:185], v33 offset:12288
    ds_read_b64_tr_b16 v[186:187], v33 offset:13312
    s_waitcnt lgkmcnt(6)
    v_mfma_f32_32x32x16_bf16 v[92:107], v[172:175], v[62:65], v[92:107]
    ds_read_b64_tr_b16 v[156:157], v30 offset:16384
    ds_read_b64_tr_b16 v[158:159], v30 offset:17408
    s_waitcnt lgkmcnt(6)
    v_mfma_f32_32x32x16_bf16 v[108:123], v[176:179], v[62:65], v[108:123]
    ds_read_b64_tr_b16 v[160:161], v31 offset:16384
    ds_read_b64_tr_b16 v[162:163], v31 offset:17408
    s_waitcnt lgkmcnt(6)
    v_mfma_f32_32x32x16_bf16 v[124:139], v[180:183], v[62:65], v[124:139]
    ds_read_b64_tr_b16 v[164:165], v32 offset:16384
    ds_read_b64_tr_b16 v[166:167], v32 offset:17408
    s_waitcnt lgkmcnt(6)
    v_mfma_f32_32x32x16_bf16 v[140:155], v[184:187], v[62:65], v[140:155]
    ds_read_b64_tr_b16 v[168:169], v33 offset:16384
    ds_read_b64_tr_b16 v[170:171], v33 offset:17408
    buffer_load_dword v12, v11, s[36:39], s61 offen sc1
    s_mov_b32 s45, 65536
    s_waitcnt vmcnt(0)
POLL_9:
    v_xor_b32 v1, s44, v12
    v_cmp_ne_u32 vcc, 0, v1
    s_sub_u32 s45, s45, 1
    s_cbranch_scc1 PDONE_10
    s_cbranch_vccz PDONE_10
    s_mov_b64 exec, vcc
    buffer_load_dword v12, v11, s[36:39], s61 offen sc1
    s_waitcnt vmcnt(0)
    s_branch POLL_9
PDONE_10:
    s_mov_b64 exec, -1
    s_bfe_u32 s50, s47, 196616
    s_lshl_b32 s50, s50, 12
    s_add_u32 s50, s50, s60
    buffer_load_dwordx4 v[16:19], v9, s[36:39], s50 offen offset:0 sc1
    buffer_load_dwordx4 v[20:23], v9, s[36:39], s50 offen offset:1024 sc1
    buffer_load_dwordx4 v[24:27], v9, s[36:39], s50 offen offset:2048 sc1
    buffer_load_dwordx4 v[66:69], v9, s[36:39], s50 offen offset:3072 sc1
    s_bfe_u32 s50, s47, 196620
    s_lshl_b32 s50, s50, 12
    s_add_u32 s50, s50, s60
    buffer_load_dwordx4 v[70:73], v9, s[36:39], s50 offen offset:0 sc1
    buffer_load_dwordx4 v[74:77], v9, s[36:39], s50 offen offset:1024 sc1
    buffer_load_dwordx4 v[78:81], v9, s[36:39], s50 offen offset:2048 sc1
    buffer_load_dwordx4 v[82:85], v9, s[36:39], s50 offen offset:3072 sc1
    s_bfe_u32 s50, s47, 196624
    s_lshl_b32 s50, s50, 12
    s_add_u32 s50, s50, s60
    buffer_load_dwordx4 v[86:89], v9, s[36:39], s50 offen offset:0 sc1
    buffer_load_dwordx4 v[188:191], v9, s[36:39], s50 offen offset:1024 sc1
    buffer_load_dwordx4 v[192:195], v9, s[36:39], s50 offen offset:2048 sc1
    buffer_load_dwordx4 v[196:199], v9, s[36:39], s50 offen offset:3072 sc1
    s_bfe_u32 s50, s47, 196628
    s_lshl_b32 s50, s50, 12
    s_add_u32 s50, s50, s60
    buffer_load_dwordx4 v[200:203], v9, s[36:39], s50 offen offset:0 sc1
    buffer_load_dwordx4 v[204:207], v9, s[36:39], s50 offen offset:1024 sc1
    buffer_load_dwordx4 v[208:211], v9, s[36:39], s50 offen offset:2048 sc1
    buffer_load_dwordx4 v[212:215], v9, s[36:39], s50 offen offset:3072 sc1
    s_bfe_u32 s50, s47, 196632
    s_lshl_b32 s50, s50, 12
    s_add_u32 s50, s50, s60
    buffer_load_dwordx4 v[216:219], v9, s[36:39], s50 offen offset:0 sc1
    buffer_load_dwordx4 v[220:223], v9, s[36:39], s50 offen offset:1024 sc1
    buffer_load_dwordx4 v[224:227], v9, s[36:39], s50 offen offset:2048 sc1
    buffer_load_dwordx4 v[228:231], v9, s[36:39], s50 offen offset:3072 sc1
    s_mov_b32 s45, 1048576
LW_11:
    ds_read_b128 v[232:235], v28 offset:16
    s_waitcnt lgkmcnt(0)
    v_min_u32 v232, v232, v233
    v_min3_u32 v232, v232, v234, v235
    v_cmp_eq_u32 vcc, 0, v232
    s_sub_u32 s45, s45, 1
    s_cbranch_scc1 LD_12
    s_cbranch_vccnz LW_11
LD_12:
    s_waitcnt vmcnt(19)
    v_mfma_f32_32x32x16_bf16 v[92:107], v[156:159], v[16:19], v[92:107]
    ds_read_b64_tr_b16 v[172:173], v30 offset:20480
    ds_read_b64_tr_b16 v[174:175], v30 offset:21504
    v_mfma_f32_32x32x16_bf16 v[108:123], v[160:163], v[16:19], v[108:123]
    ds_read_b64_tr_b16 v[176:177], v31 offset:20480
    ds_read_b64_tr_b16 v[178:179], v31 offset:21504
    v_mfma_f32_32x32x16_bf16 v[124:139], v[164:167], v[16:19], v[124:139]
    ds_read_b64_tr_b16 v[180:181], v32 offset:20480
    ds_read_b64_tr_b16 v[182:183], v32 offset:21504
    v_mfma_f32_32x32x16_bf16 v[140:155], v[168:171], v[16:19], v[140:155]
    ds_read_b64_tr_b16 v[184:185], v33 offset:20480
    ds_read_b64_tr_b16 v[186:187], v33 offset:21504
    s_waitcnt vmcnt(18)
    s_waitcnt lgkmcnt(6)
    v_mfma_f32_32x32x16_bf16 v[92:107], v[172:175], v[20:23], v[92:107]
    ds_read_b64_tr_b16 v[156:157], v30 offset:24576
    ds_read_b64_tr_b16 v[158:159], v30 offset:25600
    s_waitcnt lgkmcnt(6)
    v_mfma_f32_32x32x16_bf16 v[108:123], v[176:179], v[20:23], v[108:123]
    ds_read_b64_tr_b16 v[160:161], v31 offset:24576
    ds_read_b64_tr_b16 v[162:163], v31 offset:25600
    s_waitcnt lgkmcnt(6)
    v_mfma_f32_32x32x16_bf16 v[124:139], v[180:183], v[20:23], v[124:139]
    ds_read_b64_tr_b16 v[164:165], v32 offset:24576
    ds_read_b64_tr_b16 v[166:167], v32 offset:25600
    s_waitcnt lgkmcnt(6)
    v_mfma_f32_32x32x16_bf16 v[140:155], v[184:187], v[20:23], v[140:155]
    ds_read_b64_tr_b16 v[168:169], v33 offset:24576
    ds_read_b64_tr_b16 v[170:171], v33 offset:25600
    s_waitcnt vmcnt(17)
    s_waitcnt lgkmcnt(6)
    v_mfma_f32_32x32x16_bf16 v[92:107], v[156:159], v[24:27], v[92:107]
    ds_read_b64_tr_b16 v[172:173], v30 offset:28672
    ds_read_b64_tr_b16 v[174:175], v30 offset:29696
    s_waitcnt lgkmcnt(6)
    v_mfma_f32_32x32x16_bf16 v[108:123], v[160:163], v[24:27], v[108:123]
    ds_read_b64_tr_b16 v[176:177], v31 offset:28672
    ds_read_b64_tr_b16 v[178:179], v31 offset:29696
    s_waitcnt lgkmcnt(6)
    v_mfma_f32_32x32x16_bf16 v[124:139], v[164:167], v[24:27], v[124:139]
    ds_read_b64_tr_b16 v[180:181], v32 offset:28672
    ds_read_b64_tr_b16 v[182:183], v32 offset:29696
    s_waitcnt lgkmcnt(6)
    v_mfma_f32_32x32x16_bf16 v[140:155], v[168:171], v[24:27], v[140:155]
    ds_read_b64_tr_b16 v[184:185], v33 offset:28672
    ds_read_b64_tr_b16 v[186:187], v33 offset:29696
    s_waitcnt vmcnt(16)
    s_waitcnt lgkmcnt(6)
    v_mfma_f32_32x32x16_bf16 v[92:107], v[172:175], v[66:69], v[92:107]
    ds_read_b64_tr_b16 v[156:157], v30 offset:32768
    ds_read_b64_tr_b16 v[158:159], v30 offset:33792
    s_waitcnt lgkmcnt(6)
    v_mfma_f32_32x32x16_bf16 v[108:123], v[176:179], v[66:69], v[108:123]
    ds_read_b64_tr_b16 v[160:161], v31 offset:32768
    ds_read_b64_tr_b16 v[162:163], v31 offset:33792
    s_waitcnt lgkmcnt(6)
    v_mfma_f32_32x32x16_bf16 v[124:139], v[180:183], v[66:69], v[124:139]
    ds_read_b64_tr_b16 v[164:165], v32 offset:32768
    ds_read_b64_tr_b16 v[166:167], v32 offset:33792
    s_waitcnt lgkmcnt(6)
    v_mfma_f32_32x32x16_bf16 v[140:155], v[184:187], v[66:69], v[140:155]
    ds_read_b64_tr_b16 v[168:169], v33 offset:32768
    ds_read_b64_tr_b16 v[170:171], v33 offset:33792
    s_waitcnt vmcnt(15)
    s_waitcnt lgkmcnt(6)
    v_mfma_f32_32x32x16_bf16 v[92:107], v[156:159], v[70:73], v[92:107]
    ds_read_b64_tr_b16 v[172:173], v30 offset:36864
    ds_read_b64_tr_b16 v[174:175], v30 offset:37888
    s_waitcnt lgkmcnt(6)
    v_mfma_f32_32x32x16_bf16 v[108:123], v[160:163], v[70:73], v[108:123]
    ds_read_b64_tr_b16 v[176:177], v31 offset:36864
    ds_read_b64_tr_b16 v[178:179], v31 offset:37888
    s_waitcnt lgkmcnt(6)
    v_mfma_f32_32x32x16_bf16 v[124:139], v[164:167], v[70:73], v[124:139]
    ds_read_b64_tr_b16 v[180:181], v32 offset:36864
    ds_read_b64_tr_b16 v[182:183], v32 offset:37888
    s_waitcnt lgkmcnt(6)
    v_mfma_f32_32x32x16_bf16 v[140:155], v[168:171], v[70:73], v[140:155]
    ds_read_b64_tr_b16 v[184:185], v33 offset:36864
    ds_read_b64_tr_b16 v[186:187], v33 offset:37888
    s_waitcnt vmcnt(14)
    s_waitcnt lgkmcnt(6)
    v_mfma_f32_32x32x16_bf16 v[92:107], v[172:175], v[74:77], v[92:107]
    ds_read_b64_tr_b16 v[156:157], v30 offset:40960
    ds_read_b64_tr_b16 v[158:159], v30 offset:41984
    s_waitcnt lgkmcnt(6)
    v_mfma_f32_32x32x16_bf16 v[108:123], v[176:179], v[74:77], v[108:123]
    ds_read_b64_tr_b16 v[160:161], v31 offset:40960
    ds_read_b64_tr_b16 v[162:163], v31 offset:41984
    s_waitcnt lgkmcnt(6)
    v_mfma_f32_32x32x16_bf16 v[124:139], v[180:183], v[74:77], v[124:139]
    ds_read_b64_tr_b16 v[164:165], v32 offset:40960
    ds_read_b64_tr_b16 v[166:167], v32 offset:41984
    s_waitcnt lgkmcnt(6)
    v_mfma_f32_32x32x16_bf16 v[140:155], v[184:187], v[74:77], v[140:155]
    ds_read_b64_tr_b16 v[168:169], v33 offset:40960
    ds_read_b64_tr_b16 v[170:171], v33 offset:41984
    s_waitcnt vmcnt(13)
    s_waitcnt lgkmcnt(6)
    v_mfma_f32_32x32x16_bf16 v[92:107], v[156:159], v[78:81], v[92:107]
    ds_read_b64_tr_b16 v[172:173], v30 offset:45056
    ds_read_b64_tr_b16 v[174:175], v30 offset:46080
    s_waitcnt lgkmcnt(6)
    v_mfma_f32_32x32x16_bf16 v[108:123], v[160:163], v[78:81], v[108:123]
    ds_read_b64_tr_b16 v[176:177], v31 offset:45056
    ds_read_b64_tr_b16 v[178:179], v31 offset:46080
    s_waitcnt lgkmcnt(6)
    v_mfma_f32_32x32x16_bf16 v[124:139], v[164:167], v[78:81], v[124:139]
    ds_read_b64_tr_b16 v[180:181], v32 offset:45056
    ds_read_b64_tr_b16 v[182:183], v32 offset:46080
    s_waitcnt lgkmcnt(6)
    v_mfma_f32_32x32x16_bf16 v[140:155], v[168:171], v[78:81], v[140:155]
    ds_read_b64_tr_b16 v[184:185], v33 offset:45056
    ds_read_b64_tr_b16 v[186:187], v33 offset:46080
    s_waitcnt vmcnt(12)
    s_waitcnt lgkmcnt(6)
    v_mfma_f32_32x32x16_bf16 v[92:107], v[172:175], v[82:85], v[92:107]
    ds_read_b64_tr_b16 v[156:157], v30 offset:49152
    ds_read_b64_tr_b16 v[158:159], v30 offset:50176
    s_waitcnt lgkmcnt(6)
    v_mfma_f32_32x32x16_bf16 v[108:123], v[176:179], v[82:85], v[108:123]
    ds_read_b64_tr_b16 v[160:161], v31 offset:49152
    ds_read_b64_tr_b16 v[162:163], v31 offset:50176
    s_waitcnt lgkmcnt(6)
    v_mfma_f32_32x32x16_bf16 v[124:139], v[180:183], v[82:85], v[124:139]
    ds_read_b64_tr_b16 v[164:165], v32 offset:49152
    ds_read_b64_tr_b16 v[166:167], v32 offset:50176
    s_waitcnt lgkmcnt(6)
    v_mfma_f32_32x32x16_bf16 v[140:155], v[184:187], v[82:85], v[140:155]
    ds_read_b64_tr_b16 v[168:169], v33 offset:49152
    ds_read_b64_tr_b16 v[170:171], v33 offset:50176
    s_waitcnt vmcnt(11)
    s_waitcnt lgkmcnt(6)
    v_mfma_f32_32x32x16_bf16 v[92:107], v[156:159], v[86:89], v[92:107]
    ds_read_b64_tr_b16 v[172:173], v30 offset:53248
    ds_read_b64_tr_b16 v[174:175], v30 offset:54272
    s_waitcnt lgkmcnt(6)
    v_mfma_f32_32x32x16_bf16 v[108:123], v[160:163], v[86:89], v[108:123]
    ds_read_b64_tr_b16 v[176:177], v31 offset:53248
    ds_read_b64_tr_b16 v[178:179], v31 offset:54272
    s_waitcnt lgkmcnt(6)
    v_mfma_f32_32x32x16_bf16 v[124:139], v[164:167], v[86:89], v[124:139]
    ds_read_b64_tr_b16 v[180:181], v32 offset:53248
    ds_read_b64_tr_b16 v[182:183], v32 offset:54272
    s_waitcnt lgkmcnt(6)
    v_mfma_f32_32x32x16_bf16 v[140:155], v[168:171], v[86:89], v[140:155]
    ds_read_b64_tr_b16 v[184:185], v33 offset:53248
    ds_read_b64_tr_b16 v[186:187], v33 offset:54272
    s_waitcnt vmcnt(10)
    s_waitcnt lgkmcnt(6)
    v_mfma_f32_32x32x16_bf16 v[92:107], v[172:175], v[188:191], v[92:107]
    ds_read_b64_tr_b16 v[156:157], v30 offset:57344
    ds_read_b64_tr_b16 v[158:159], v30 offset:58368
    s_waitcnt lgkmcnt(6)
    v_mfma_f32_32x32x16_bf16 v[108:123], v[176:179], v[188:191], v[108:123]
    ds_read_b64_tr_b16 v[160:161], v31 offset:57344
    ds_read_b64_tr_b16 v[162:163], v31 offset:58368
    s_waitcnt lgkmcnt(6)
    v_mfma_f32_32x32x16_bf16 v[124:139], v[180:183], v[188:191], v[124:139]
    ds_read_b64_tr_b16 v[164:165], v32 offset:57344
    ds_read_b64_tr_b16 v[166:167], v32 offset:58368
    s_waitcnt lgkmcnt(6)
    v_mfma_f32_32x32x16_bf16 v[140:155], v[184:187], v[188:191], v[140:155]
    ds_read_b64_tr_b16 v[168:169], v33 offset:57344
    ds_read_b64_tr_b16 v[170:171], v33 offset:58368
    s_waitcnt vmcnt(9)
    s_waitcnt lgkmcnt(6)
    v_mfma_f32_32x32x16_bf16 v[92:107], v[156:159], v[192:195], v[92:107]
    ds_read_b64_tr_b16 v[172:173], v30 offset:61440
    ds_read_b64_tr_b16 v[174:175], v30 offset:62464
    s_waitcnt lgkmcnt(6)
    v_mfma_f32_32x32x16_bf16 v[108:123], v[160:163], v[192:195], v[108:123]
    ds_read_b64_tr_b16 v[176:177], v31 offset:61440
    ds_read_b64_tr_b16 v[178:179], v31 offset:62464
    s_waitcnt lgkmcnt(6)
    v_mfma_f32_32x32x16_bf16 v[124:139], v[164:167], v[192:195], v[124:139]
    ds_read_b64_tr_b16 v[180:181], v32 offset:61440
    ds_read_b64_tr_b16 v[182:183], v32 offset:62464
    s_waitcnt lgkmcnt(6)
    v_mfma_f32_32x32x16_bf16 v[140:155], v[168:171], v[192:195], v[140:155]
    ds_read_b64_tr_b16 v[184:185], v33 offset:61440
    ds_read_b64_tr_b16 v[186:187], v33 offset:62464
    s_waitcnt vmcnt(8)
    v_xor_b32 v30, 0x10000, v30
    v_xor_b32 v31, 0x10000, v31
    v_xor_b32 v32, 0x10000, v32
    v_xor_b32 v33, 0x10000, v33
    s_waitcnt lgkmcnt(6)
    v_mfma_f32_32x32x16_bf16 v[92:107], v[172:175], v[196:199], v[92:107]
    ds_read_b64_tr_b16 v[156:157], v30 offset:0
    ds_read_b64_tr_b16 v[158:159], v30 offset:1024
    s_waitcnt lgkmcnt(6)
    v_mfma_f32_32x32x16_bf16 v[108:123], v[176:179], v[196:199], v[108:123]
    ds_read_b64_tr_b16 v[160:161], v31 offset:0
    ds_read_b64_tr_b16 v[162:163], v31 offset:1024
    s_waitcnt lgkmcnt(6)
    v_mfma_f32_32x32x16_bf16 v[124:139], v[180:183], v[196:199], v[124:139]
    ds_read_b64_tr_b16 v[164:165], v32 offset:0
    ds_read_b64_tr_b16 v[166:167], v32 offset:1024
    s_waitcnt lgkmcnt(6)
    v_mfma_f32_32x32x16_bf16 v[140:155], v[184:187], v[196:199], v[140:155]
    ds_read_b64_tr_b16 v[168:169], v33 offset:0
    ds_read_b64_tr_b16 v[170:171], v33 offset:1024
    s_waitcnt vmcnt(7)
    s_waitcnt lgkmcnt(6)
    v_mfma_f32_32x32x16_bf16 v[92:107], v[156:159], v[200:203], v[92:107]
    ds_read_b64_tr_b16 v[172:173], v30 offset:4096
    ds_read_b64_tr_b16 v[174:175], v30 offset:5120
    s_waitcnt lgkmcnt(6)
    v_mfma_f32_32x32x16_bf16 v[108:123], v[160:163], v[200:203], v[108:123]
    ds_read_b64_tr_b16 v[176:177], v31 offset:4096
    ds_read_b64_tr_b16 v[178:179], v31 offset:5120
    s_waitcnt lgkmcnt(6)
    v_mfma_f32_32x32x16_bf16 v[124:139], v[164:167], v[200:203], v[124:139]
    ds_read_b64_tr_b16 v[180:181], v32 offset:4096
    ds_read_b64_tr_b16 v[182:183], v32 offset:5120
    s_waitcnt lgkmcnt(6)
    v_mfma_f32_32x32x16_bf16 v[140:155], v[168:171], v[200:203], v[140:155]
    ds_read_b64_tr_b16 v[184:185], v33 offset:4096
    ds_read_b64_tr_b16 v[186:187], v33 offset:5120
    s_waitcnt vmcnt(6)
    s_waitcnt lgkmcnt(6)
    v_mfma_f32_32x32x16_bf16 v[92:107], v[172:175], v[204:207], v[92:107]
    ds_read_b64_tr_b16 v[156:157], v30 offset:8192
    ds_read_b64_tr_b16 v[158:159], v30 offset:9216
    s_waitcnt lgkmcnt(6)
    v_mfma_f32_32x32x16_bf16 v[108:123], v[176:179], v[204:207], v[108:123]
    ds_read_b64_tr_b16 v[160:161], v31 offset:8192
    ds_read_b64_tr_b16 v[162:163], v31 offset:9216
    s_waitcnt lgkmcnt(6)
    v_mfma_f32_32x32x16_bf16 v[124:139], v[180:183], v[204:207], v[124:139]
    ds_read_b64_tr_b16 v[164:165], v32 offset:8192
    ds_read_b64_tr_b16 v[166:167], v32 offset:9216
    s_waitcnt lgkmcnt(6)
    v_mfma_f32_32x32x16_bf16 v[140:155], v[184:187], v[204:207], v[140:155]
    ds_read_b64_tr_b16 v[168:169], v33 offset:8192
    ds_read_b64_tr_b16 v[170:171], v33 offset:9216
    s_waitcnt vmcnt(5)
    s_waitcnt lgkmcnt(6)
    v_mfma_f32_32x32x16_bf16 v[92:107], v[156:159], v[208:211], v[92:107]
    ds_read_b64_tr_b16 v[172:173], v30 offset:12288
    ds_read_b64_tr_b16 v[174:175], v30 offset:13312
    s_waitcnt lgkmcnt(6)
    v_mfma_f32_32x32x16_bf16 v[108:123], v[160:163], v[208:211], v[108:123]
    ds_read_b64_tr_b16 v[176:177], v31 offset:12288
    ds_read_b64_tr_b16 v[178:179], v31 offset:13312
    s_waitcnt lgkmcnt(6)
    v_mfma_f32_32x32x16_bf16 v[124:139], v[164:167], v[208:211], v[124:139]
    ds_read_b64_tr_b16 v[180:181], v32 offset:12288
    ds_read_b64_tr_b16 v[182:183], v32 offset:13312
    s_waitcnt lgkmcnt(6)
    v_mfma_f32_32x32x16_bf16 v[140:155], v[168:171], v[208:211], v[140:155]
    ds_read_b64_tr_b16 v[184:185], v33 offset:12288
    ds_read_b64_tr_b16 v[186:187], v33 offset:13312
    s_waitcnt vmcnt(4)
    s_waitcnt lgkmcnt(6)
    v_mfma_f32_32x32x16_bf16 v[92:107], v[172:175], v[212:215], v[92:107]
    ds_read_b64_tr_b16 v[156:157], v30 offset:16384
    ds_read_b64_tr_b16 v[158:159], v30 offset:17408
    s_waitcnt lgkmcnt(6)
    v_mfma_f32_32x32x16_bf16 v[108:123], v[176:179], v[212:215], v[108:123]
    ds_read_b64_tr_b16 v[160:161], v31 offset:16384
    ds_read_b64_tr_b16 v[162:163], v31 offset:17408
    s_waitcnt lgkmcnt(6)
    v_mfma_f32_32x32x16_bf16 v[124:139], v[180:183], v[212:215], v[124:139]
    ds_read_b64_tr_b16 v[164:165], v32 offset:16384
    ds_read_b64_tr_b16 v[166:167], v32 offset:17408
    s_waitcnt lgkmcnt(6)
    v_mfma_f32_32x32x16_bf16 v[140:155], v[184:187], v[212:215], v[140:155]
    ds_read_b64_tr_b16 v[168:169], v33 offset:16384
    ds_read_b64_tr_b16 v[170:171], v33 offset:17408
    s_waitcnt vmcnt(3)
    s_waitcnt lgkmcnt(6)
    v_mfma_f32_32x32x16_bf16 v[92:107], v[156:159], v[216:219], v[92:107]
    ds_read_b64_tr_b16 v[172:173], v30 offset:20480
    ds_read_b64_tr_b16 v[174:175], v30 offset:21504
    s_waitcnt lgkmcnt(6)
    v_mfma_f32_32x32x16_bf16 v[108:123], v[160:163], v[216:219], v[108:123]
    ds_read_b64_tr_b16 v[176:177], v31 offset:20480
    ds_read_b64_tr_b16 v[178:179], v31 offset:21504
    s_waitcnt lgkmcnt(6)
    v_mfma_f32_32x32x16_bf16 v[124:139], v[164:167], v[216:219], v[124:139]
    ds_read_b64_tr_b16 v[180:181], v32 offset:20480
    ds_read_b64_tr_b16 v[182:183], v32 offset:21504
    s_waitcnt lgkmcnt(6)
    v_mfma_f32_32x32x16_bf16 v[140:155], v[168:171], v[216:219], v[140:155]
    ds_read_b64_tr_b16 v[184:185], v33 offset:20480
    ds_read_b64_tr_b16 v[186:187], v33 offset:21504
    s_waitcnt vmcnt(2)
    s_waitcnt lgkmcnt(6)
    v_mfma_f32_32x32x16_bf16 v[92:107], v[172:175], v[220:223], v[92:107]
    ds_read_b64_tr_b16 v[156:157], v30 offset:24576
    ds_read_b64_tr_b16 v[158:159], v30 offset:25600
    s_waitcnt lgkmcnt(6)
    v_mfma_f32_32x32x16_bf16 v[108:123], v[176:179], v[220:223], v[108:123]
    ds_read_b64_tr_b16 v[160:161], v31 offset:24576
    ds_read_b64_tr_b16 v[162:163], v31 offset:25600
    s_waitcnt lgkmcnt(6)
    v_mfma_f32_32x32x16_bf16 v[124:139], v[180:183], v[220:223], v[124:139]
    ds_read_b64_tr_b16 v[164:165], v32 offset:24576
    ds_read_b64_tr_b16 v[166:167], v32 offset:25600
    s_waitcnt lgkmcnt(6)
    v_mfma_f32_32x32x16_bf16 v[140:155], v[184:187], v[220:223], v[140:155]
    ds_read_b64_tr_b16 v[168:169], v33 offset:24576
    ds_read_b64_tr_b16 v[170:171], v33 offset:25600
    s_waitcnt vmcnt(1)
    s_waitcnt lgkmcnt(6)
    v_mfma_f32_32x32x16_bf16 v[92:107], v[156:159], v[224:227], v[92:107]
    ds_read_b64_tr_b16 v[172:173], v30 offset:28672
    ds_read_b64_tr_b16 v[174:175], v30 offset:29696
    s_waitcnt lgkmcnt(6)
    v_mfma_f32_32x32x16_bf16 v[108:123], v[160:163], v[224:227], v[108:123]
    ds_read_b64_tr_b16 v[176:177], v31 offset:28672
    ds_read_b64_tr_b16 v[178:179], v31 offset:29696
    s_waitcnt lgkmcnt(6)
    v_mfma_f32_32x32x16_bf16 v[124:139], v[164:167], v[224:227], v[124:139]
    ds_read_b64_tr_b16 v[180:181], v32 offset:28672
    ds_read_b64_tr_b16 v[182:183], v32 offset:29696
    s_waitcnt lgkmcnt(6)
    v_mfma_f32_32x32x16_bf16 v[140:155], v[168:171], v[224:227], v[140:155]
    ds_read_b64_tr_b16 v[184:185], v33 offset:28672
    ds_read_b64_tr_b16 v[186:187], v33 offset:29696
    s_waitcnt vmcnt(0)
    s_waitcnt lgkmcnt(6)
    v_mfma_f32_32x32x16_bf16 v[92:107], v[172:175], v[228:231], v[92:107]
    s_waitcnt lgkmcnt(4)
    v_mfma_f32_32x32x16_bf16 v[108:123], v[176:179], v[228:231], v[108:123]
    s_waitcnt lgkmcnt(2)
    v_mfma_f32_32x32x16_bf16 v[124:139], v[180:183], v[228:231], v[124:139]
    s_waitcnt lgkmcnt(0)
    v_mfma_f32_32x32x16_bf16 v[140:155], v[184:187], v[228:231], v[140:155]
    s_lshl_b32 s48, s42, 4
    s_add_u32 s48, s48, s43
    s_lshl_b32 s48, s48, 2
    s_add_u32 s48, s48, s3
    s_lshl_b32 s48, s48, 13
    s_add_u32 s48, s48, 14090240
    s_add_u32 s49, s48, 4096
    s_lshl_b32 s50, s42, 2
    s_add_u32 s50, s50, s41
    s_lshl_b32 s50, s50, 11
    s_lshl_b32 s51, s3, 9
    s_add_u32 s50, s50, s51
    s_lshl_b32 s51, s40, 7
    s_add_u32 s50, s50, s51
    s_add_u32 s50, s50, 22872064
    v_add_u32 v1, 139264, v9
    s_nop 7
    s_cmp_eq_u32 s3, s40
    s_cbranch_scc1 OWN_13
    v_cvt_pk_bf16_f32 v34, v92, v93
    v_cvt_pk_bf16_f32 v35, v94, v95
    v_cvt_pk_bf16_f32 v36, v96, v97
    v_cvt_pk_bf16_f32 v37, v98, v99
    buffer_store_dwordx4 v[34:37], v9, s[36:39], s48 offen offset:0 sc1
    v_cvt_pk_bf16_f32 v38, v100, v101
    v_cvt_pk_bf16_f32 v39, v102, v103
    v_cvt_pk_bf16_f32 v40, v104, v105
    v_cvt_pk_bf16_f32 v41, v106, v107
    buffer_store_dwordx4 v[38:41], v9, s[36:39], s48 offen offset:1024 sc1
    v_cvt_pk_bf16_f32 v42, v108, v109
    v_cvt_pk_bf16_f32 v43, v110, v111
    v_cvt_pk_bf16_f32 v44, v112, v113
    v_cvt_pk_bf16_f32 v45, v114, v115
    buffer_store_dwordx4 v[42:45], v9, s[36:39], s48 offen offset:2048 sc1
    v_cvt_pk_bf16_f32 v46, v116, v117
    v_cvt_pk_bf16_f32 v47, v118, v119
    v_cvt_pk_bf16_f32 v48, v120, v121
    v_cvt_pk_bf16_f32 v49, v122, v123
    buffer_store_dwordx4 v[46:49], v9, s[36:39], s48 offen offset:3072 sc1
    v_cvt_pk_bf16_f32 v50, v124, v125
    v_cvt_pk_bf16_f32 v51, v126, v127
    v_cvt_pk_bf16_f32 v52, v128, v129
    v_cvt_pk_bf16_f32 v53, v130, v131
    buffer_store_dwordx4 v[50:53], v9, s[36:39], s49 offen offset:0 sc1
    v_cvt_pk_bf16_f32 v54, v132, v133
    v_cvt_pk_bf16_f32 v55, v134, v135
    v_cvt_pk_bf16_f32 v56, v136, v137
    v_cvt_pk_bf16_f32 v57, v138, v139
    buffer_store_dwordx4 v[54:57], v9, s[36:39], s49 offen offset:1024 sc1
    v_cvt_pk_bf16_f32 v58, v140, v141
    v_cvt_pk_bf16_f32 v59, v142, v143
    v_cvt_pk_bf16_f32 v60, v144, v145
    v_cvt_pk_bf16_f32 v61, v146, v147
    buffer_store_dwordx4 v[58:61], v9, s[36:39], s49 offen offset:2048 sc1
    v_cvt_pk_bf16_f32 v62, v148, v149
    v_cvt_pk_bf16_f32 v63, v150, v151
    v_cvt_pk_bf16_f32 v64, v152, v153
    v_cvt_pk_bf16_f32 v65, v154, v155
    buffer_store_dwordx4 v[62:65], v9, s[36:39], s49 offen offset:3072 sc1
    s_branch JOIN_14
OWN_13:
    v_cvt_pk_bf16_f32 v34, v92, v93
    v_cvt_pk_bf16_f32 v35, v94, v95
    v_cvt_pk_bf16_f32 v36, v96, v97
    v_cvt_pk_bf16_f32 v37, v98, v99
    ds_write_b128 v1, v[34:37] offset:0
    v_cvt_pk_bf16_f32 v38, v100, v101
    v_cvt_pk_bf16_f32 v39, v102, v103
    v_cvt_pk_bf16_f32 v40, v104, v105
    v_cvt_pk_bf16_f32 v41, v106, v107
    ds_write_b128 v1, v[38:41] offset:1024
    v_cvt_pk_bf16_f32 v42, v108, v109
    v_cvt_pk_bf16_f32 v43, v110, v111
    v_cvt_pk_bf16_f32 v44, v112, v113
    v_cvt_pk_bf16_f32 v45, v114, v115
    ds_write_b128 v1, v[42:45] offset:2048
    v_cvt_pk_bf16_f32 v46, v116, v117
    v_cvt_pk_bf16_f32 v47, v118, v119
    v_cvt_pk_bf16_f32 v48, v120, v121
    v_cvt_pk_bf16_f32 v49, v122, v123
    ds_write_b128 v1, v[46:49] offset:3072
    v_cvt_pk_bf16_f32 v50, v124, v125
    v_cvt_pk_bf16_f32 v51, v126, v127
    v_cvt_pk_bf16_f32 v52, v128, v129
    v_cvt_pk_bf16_f32 v53, v130, v131
    ds_write_b128 v1, v[50:53] offset:4096
    v_cvt_pk_bf16_f32 v54, v132, v133
    v_cvt_pk_bf16_f32 v55, v134, v135
    v_cvt_pk_bf16_f32 v56, v136, v137
    v_cvt_pk_bf16_f32 v57, v138, v139
    ds_write_b128 v1, v[54:57] offset:5120
    v_cvt_pk_bf16_f32 v58, v140, v141
    v_cvt_pk_bf16_f32 v59, v142, v143
    v_cvt_pk_bf16_f32 v60, v144, v145
    v_cvt_pk_bf16_f32 v61, v146, v147
    ds_write_b128 v1, v[58:61] offset:6144
    v_cvt_pk_bf16_f32 v62, v148, v149
    v_cvt_pk_bf16_f32 v63, v150, v151
    v_cvt_pk_bf16_f32 v64, v152, v153
    v_cvt_pk_bf16_f32 v65, v154, v155
    ds_write_b128 v1, v[62:65] offset:7168
JOIN_14:
    s_waitcnt vmcnt(0) lgkmcnt(0)
    buffer_store_dword v15, v10, s[36:39], s50 offen sc1
    s_endpgm
HELPER:
    s_setprio 1
    v_lshlrev_b32 v1, 15, v6
    v_lshl_add_u32 v1, v5, 4, v1
    s_lshl_b32 s48, s42, 7
    s_and_b32 s49, s3, 1
    s_lshl_b32 s49, s49, 6
    s_add_u32 s48, s48, s49
    s_lshl_b32 s49, s40, 3
    s_add_u32 s48, s48, s49
    s_lshl_b32 s49, s41, 1
    s_add_u32 s48, s48, s49
    s_lshr_b32 s49, s3, 1
    s_add_u32 s48, s48, s49
    s_lshl_b32 s48, s48, 10
    s_waitcnt lgkmcnt(0)
    s_load_dword s44, s[36:37], 0
    buffer_load_dwordx4 v[24:27], v1, s[4:7], s48 offen
    buffer_load_dwordx4 v[28:31], v1, s[4:7], s48 offen offset:512
    s_lshl_b32 s43, s40, 2
    s_add_u32 s43, s43, s41
    s_mov_b32 s47, 87441936
    s_cmp_eq_u32 s41, 1
    s_cselect_b32 s47, 22045746, s47
    s_cmp_eq_u32 s41, 2
    s_cselect_b32 s47, 51512916, s47
    s_cmp_eq_u32 s41, 3
    s_cselect_b32 s47, 87114246, s47
    v_bfe_u32 v1, v5, 1, 3
    v_xor_b32 v1, v1, v6
    v_lshlrev_b32 v1, 4, v1
    v_lshl_add_u32 v1, v5, 7, v1
    v_add_u32 v32, s58, v1
    v_xor_b32 v33, 32, v32
    v_xor_b32 v34, 64, v32
    v_xor_b32 v35, 96, v32
    v_bfe_u32 v1, v4, 2, 2
    v_mul_u32_u24 v1, 320, v1
    v_lshl_add_u32 v1, v6, 11, v1
    v_and_b32 v2, 16, v4
    v_lshl_add_u32 v1, v2, 1, v1
    v_and_b32 v2, 1, v4
    v_lshl_add_u32 v1, v2, 4, v1
    v_and_b32 v2, 2, v4
    v_lshl_add_u32 v23, v2, 2, v1
    v_mov_b32 v36, 133120
    v_lshlrev_b32 v37, 4, v5
    s_lshl_b32 s48, s42, 2
    s_add_u32 s48, s48, s3
    s_lshl_b32 s48, s48, 9
    s_add_u32 s59, s48, 32768
    s_lshl_b32 s48, s3, 6
    v_xor_b32 v23, s48, v23
    v_add_u32 v20, 3072, v19
    v_add_u32 v21, 6144, v19
    v_add_u32 v22, 9216, v19
    v_mov_b32 v2, 0
    v_lshl_add_u32 v1, v5, 2, v36
    ds_write_b32 v1, v2
    s_lshl_b32 s48, s3, 2
    v_add_u32 v38, s48, v36
    v_lshrrev_b32 v1, 2, v4
    v_xor_b32 v1, v1, v7
    v_and_b32 v1, 1, v1
    v_subrev_u32 v1, 1, v1
    v_and_b32 v88, 0x3f803f80, v1
    v_and_b32 v89, 0x3f803f80, v1
    v_and_b32 v90, 0x3f803f80, v1
    v_and_b32 v91, 0x3f803f80, v1
    s_mov_b32 s49, 0x36000000
    s_cmp_eq_u32 s2, 255
    s_cselect_b32 s60, 0x35800000, s49
    v_cvt_f32_u32 v152, v8
    v_lshlrev_b32 v39, 2, v7
    v_cvt_f32_u32 v153, v39
    v_cvt_f32_u32 v57, s3
    v_fmamk_f32 v154, v57, 0x41800000, v152
    v_mul_f32 v39, 0x3d000000, v152
    v_mul_f32 v56, v39, v153
    v_fmamk_f32 v48, v39, 0x00000000, v56
    v_fmamk_f32 v49, v39, 0x3f800000, v56
    v_fmamk_f32 v50, v39, 0x40000000, v56
    v_fmamk_f32 v51, v39, 0x40400000, v56
    v_fmamk_f32 v52, v39, 0x41800000, v56
    v_fmamk_f32 v53, v39, 0x41880000, v56
    v_fmamk_f32 v54, v39, 0x41900000, v56
    v_fmamk_f32 v55, v39, 0x41980000, v56
    v_cos_f32 v40, v48
    v_sin_f32 v48, v48
    v_cos_f32 v41, v49
    v_sin_f32 v49, v49
    v_cos_f32 v42, v50
    v_sin_f32 v50, v50
    v_cos_f32 v43, v51
    v_sin_f32 v51, v51
    v_cos_f32 v44, v52
    v_sin_f32 v52, v52
    v_cos_f32 v45, v53
    v_sin_f32 v53, v53
    v_cos_f32 v46, v54
    v_sin_f32 v54, v54
    v_cos_f32 v47, v55
    v_sin_f32 v55, v55
    v_cvt_pk_bf16_f32 v156, v40, v41
    v_cvt_pk_bf16_f32 v164, v48, v49
    v_cvt_pk_bf16_f32 v157, v42, v43
    v_cvt_pk_bf16_f32 v165, v50, v51
    v_cvt_pk_bf16_f32 v158, v44, v45
    v_cvt_pk_bf16_f32 v166, v52, v53
    v_cvt_pk_bf16_f32 v159, v46, v47
    v_cvt_pk_bf16_f32 v167, v54, v55
    v_xor_b32 v172, 0x80008000, v164
    v_xor_b32 v160, 0x80000000, v156
    v_xor_b32 v168, 0x80000000, v164
    v_xor_b32 v176, 0x00008000, v164
    v_xor_b32 v173, 0x80008000, v165
    v_xor_b32 v161, 0x80000000, v157
    v_xor_b32 v169, 0x80000000, v165
    v_xor_b32 v177, 0x00008000, v165
    v_xor_b32 v174, 0x80008000, v166
    v_xor_b32 v162, 0x80000000, v158
    v_xor_b32 v170, 0x80000000, v166
    v_xor_b32 v178, 0x00008000, v166
    v_xor_b32 v175, 0x80008000, v167
    v_xor_b32 v163, 0x80000000, v159
    v_xor_b32 v171, 0x80000000, v167
    v_xor_b32 v179, 0x00008000, v167
    v_mul_f32 v39, 0x3c800000, v154
    v_mul_f32 v56, v39, v153
    v_fmamk_f32 v48, v39, 0x00000000, v56
    v_fmamk_f32 v49, v39, 0x3f800000, v56
    v_fmamk_f32 v50, v39, 0x40000000, v56
    v_fmamk_f32 v51, v39, 0x40400000, v56
    v_fmamk_f32 v52, v39, 0x41800000, v56
    v_fmamk_f32 v53, v39, 0x41880000, v56
    v_fmamk_f32 v54, v39, 0x41900000, v56
    v_fmamk_f32 v55, v39, 0x41980000, v56
    v_cos_f32 v40, v48
    v_sin_f32 v48, v48
    v_cos_f32 v41, v49
    v_sin_f32 v49, v49
    v_cos_f32 v42, v50
    v_sin_f32 v50, v50
    v_cos_f32 v43, v51
    v_sin_f32 v51, v51
    v_cos_f32 v44, v52
    v_sin_f32 v52, v52
    v_cos_f32 v45, v53
    v_sin_f32 v53, v53
    v_cos_f32 v46, v54
    v_sin_f32 v54, v54
    v_cos_f32 v47, v55
    v_sin_f32 v55, v55
    v_cvt_pk_bf16_f32 v112, v40, v48
    v_cvt_pk_bf16_f32 v128, -v48, v40
    v_cvt_pk_bf16_f32 v113, v41, v49
    v_cvt_pk_bf16_f32 v129, -v49, v41
    v_cvt_pk_bf16_f32 v114, v42, v50
    v_cvt_pk_bf16_f32 v130, -v50, v42
    v_cvt_pk_bf16_f32 v115, v43, v51
    v_cvt_pk_bf16_f32 v131, -v51, v43
    v_cvt_pk_bf16_f32 v116, v44, v52
    v_cvt_pk_bf16_f32 v132, -v52, v44
    v_cvt_pk_bf16_f32 v117, v45, v53
    v_cvt_pk_bf16_f32 v133, -v53, v45
    v_cvt_pk_bf16_f32 v118, v46, v54
    v_cvt_pk_bf16_f32 v134, -v54, v46
    v_cvt_pk_bf16_f32 v119, v47, v55
    v_cvt_pk_bf16_f32 v135, -v55, v47
    v_fmamk_f32 v48, v39, 0x42000000, v56
    v_fmamk_f32 v49, v39, 0x42040000, v56
    v_fmamk_f32 v50, v39, 0x42080000, v56
    v_fmamk_f32 v51, v39, 0x420c0000, v56
    v_fmamk_f32 v52, v39, 0x42400000, v56
    v_fmamk_f32 v53, v39, 0x42440000, v56
    v_fmamk_f32 v54, v39, 0x42480000, v56
    v_fmamk_f32 v55, v39, 0x424c0000, v56
    v_cos_f32 v40, v48
    v_sin_f32 v48, v48
    v_cos_f32 v41, v49
    v_sin_f32 v49, v49
    v_cos_f32 v42, v50
    v_sin_f32 v50, v50
    v_cos_f32 v43, v51
    v_sin_f32 v51, v51
    v_cos_f32 v44, v52
    v_sin_f32 v52, v52
    v_cos_f32 v45, v53
    v_sin_f32 v53, v53
    v_cos_f32 v46, v54
    v_sin_f32 v54, v54
    v_cos_f32 v47, v55
    v_sin_f32 v55, v55
    v_cvt_pk_bf16_f32 v120, v40, v48
    v_cvt_pk_bf16_f32 v136, -v48, v40
    v_cvt_pk_bf16_f32 v121, v41, v49
    v_cvt_pk_bf16_f32 v137, -v49, v41
    v_cvt_pk_bf16_f32 v122, v42, v50
    v_cvt_pk_bf16_f32 v138, -v50, v42
    v_cvt_pk_bf16_f32 v123, v43, v51
    v_cvt_pk_bf16_f32 v139, -v51, v43
    v_cvt_pk_bf16_f32 v124, v44, v52
    v_cvt_pk_bf16_f32 v140, -v52, v44
    v_cvt_pk_bf16_f32 v125, v45, v53
    v_cvt_pk_bf16_f32 v141, -v53, v45
    v_cvt_pk_bf16_f32 v126, v46, v54
    v_cvt_pk_bf16_f32 v142, -v54, v46
    v_cvt_pk_bf16_f32 v127, v47, v55
    v_cvt_pk_bf16_f32 v143, -v55, v47
    v_mul_f32 v39, 0x3a000000, v154
    v_mul_f32 v56, v39, v153
    v_fmamk_f32 v188, v39, 0x00000000, v56
    v_fmamk_f32 v189, v39, 0x3f800000, v56
    v_fmamk_f32 v190, v39, 0x40000000, v56
    v_fmamk_f32 v191, v39, 0x40400000, v56
    v_fmamk_f32 v192, v39, 0x41800000, v56
    v_fmamk_f32 v193, v39, 0x41880000, v56
    v_fmamk_f32 v194, v39, 0x41900000, v56
    v_fmamk_f32 v195, v39, 0x41980000, v56
    v_cos_f32 v180, v188
    v_sin_f32 v188, v188
    v_cos_f32 v181, v189
    v_sin_f32 v189, v189
    v_cos_f32 v182, v190
    v_sin_f32 v190, v190
    v_cos_f32 v183, v191
    v_sin_f32 v191, v191
    v_cos_f32 v184, v192
    v_sin_f32 v192, v192
    v_cos_f32 v185, v193
    v_sin_f32 v193, v193
    v_cos_f32 v186, v194
    v_sin_f32 v194, v194
    v_cos_f32 v187, v195
    v_sin_f32 v195, v195
    v_fmamk_f32 v57, v57, 0x41800000, v153
    v_add_f32 v39, 0x00000000, v152
    v_mul_f32 v39, 0x3a000000, v39
    v_mul_f32 v56, v39, v57
    v_fmamk_f32 v204, v39, 0x00000000, v56
    v_fmamk_f32 v205, v39, 0x3f800000, v56
    v_fmamk_f32 v206, v39, 0x40000000, v56
    v_fmamk_f32 v207, v39, 0x40400000, v56
    v_cos_f32 v196, v204
    v_sin_f32 v204, v204
    v_cos_f32 v197, v205
    v_sin_f32 v205, v205
    v_cos_f32 v198, v206
    v_sin_f32 v206, v206
    v_cos_f32 v199, v207
    v_sin_f32 v207, v207
    v_add_f32 v39, 0x41800000, v152
    v_mul_f32 v39, 0x3a000000, v39
    v_mul_f32 v56, v39, v57
    v_fmamk_f32 v208, v39, 0x00000000, v56
    v_fmamk_f32 v209, v39, 0x3f800000, v56
    v_fmamk_f32 v210, v39, 0x40000000, v56
    v_fmamk_f32 v211, v39, 0x40400000, v56
    v_cos_f32 v200, v208
    v_sin_f32 v208, v208
    v_cos_f32 v201, v209
    v_sin_f32 v209, v209
    v_cos_f32 v202, v210
    v_sin_f32 v210, v210
    v_cos_f32 v203, v211
    v_sin_f32 v211, v211
    v_mul_f32 v196, s60, v196
    v_mul_f32 v204, s60, v204
    v_mul_f32 v197, s60, v197
    v_mul_f32 v205, s60, v205
    v_mul_f32 v198, s60, v198
    v_mul_f32 v206, s60, v206
    v_mul_f32 v199, s60, v199
    v_mul_f32 v207, s60, v207
    v_mul_f32 v200, s60, v200
    v_mul_f32 v208, s60, v208
    v_mul_f32 v201, s60, v201
    v_mul_f32 v209, s60, v209
    v_mul_f32 v202, s60, v202
    v_mul_f32 v210, s60, v210
    v_mul_f32 v203, s60, v203
    v_mul_f32 v211, s60, v211
    s_add_u32 s50, s46, 1
    s_and_b32 s50, s50, 7
    s_mul_i32 s51, s50, 229376
    s_add_u32 s51, s51, s56
    s_lshl_b32 s50, s50, 7
    s_add_u32 m0, s58, 32768
    s_add_u32 s50, s50, s55
    buffer_load_dwordx4 v11, s[4:7], s50 offen offset:0 lds
    buffer_load_dwordx4 v12, s[4:7], s50 offen offset:1024 lds
    buffer_load_dwordx4 v13, s[4:7], s50 offen offset:2048 lds
    buffer_load_dwordx4 v14, s[4:7], s50 offen offset:3072 lds
    s_add_u32 m0, s58, 49152
    s_nop 0
    buffer_load_dwordx4 v15, s[16:19], s51 offen offset:0 lds
    buffer_load_dwordx4 v16, s[16:19], s51 offen offset:1024 lds
    buffer_load_dwordx4 v17, s[16:19], s51 offen offset:2048 lds
    buffer_load_dwordx4 v18, s[16:19], s51 offen offset:3072 lds
    s_waitcnt lgkmcnt(0)
    s_mul_i32 s44, s44, 1664525
    s_add_u32 s44, s44, 1013904223
    v_mov_b32 v87, s44
    s_waitcnt vmcnt(8)
    v_lshlrev_b32 v96, 16, v24
    v_and_b32 v97, 0xffff0000, v24
    v_lshlrev_b32 v98, 16, v25
    v_and_b32 v99, 0xffff0000, v25
    v_lshlrev_b32 v100, 16, v26
    v_and_b32 v101, 0xffff0000, v26
    v_lshlrev_b32 v102, 16, v27
    v_and_b32 v103, 0xffff0000, v27
    v_lshlrev_b32 v104, 16, v28
    v_and_b32 v105, 0xffff0000, v28
    v_lshlrev_b32 v106, 16, v29
    v_and_b32 v107, 0xffff0000, v29
    v_lshlrev_b32 v108, 16, v30
    v_and_b32 v109, 0xffff0000, v30
    v_lshlrev_b32 v110, 16, v31
    v_and_b32 v111, 0xffff0000, v31
    v_pk_add_f32 v[144:145], v[96:97], v[98:99]
    v_pk_add_f32 v[146:147], v[100:101], v[102:103]
    v_pk_add_f32 v[144:145], v[144:145], v[104:105]
    v_pk_add_f32 v[146:147], v[146:147], v[106:107]
    v_pk_add_f32 v[144:145], v[144:145], v[108:109]
    v_pk_add_f32 v[146:147], v[146:147], v[110:111]
    v_pk_add_f32 v[144:145], v[144:145], v[146:147]
    v_add_f32 v144, v144, v145
    s_nop 1
    v_add_f32_dpp v144, v144, v144 row_ror:8 row_mask:0xf bank_mask:0xf
    s_nop 1
    v_add_f32_dpp v144, v144, v144 row_ror:4 row_mask:0xf bank_mask:0xf
    s_nop 1
    v_add_f32_dpp v144, v144, v144 row_ror:2 row_mask:0xf bank_mask:0xf
    s_nop 1
    v_add_f32_dpp v144, v144, v144 row_ror:1 row_mask:0xf bank_mask:0xf
    v_mov_b32 v145, v144
    s_nop 1
    v_permlane16_swap_b32 v144, v145
    v_add_f32 v144, v144, v145
    v_mul_f32 v148, 0x3b000000, v144
    v_mov_b32 v149, s44
    v_mov_b32 v151, s44
    v_pk_add_f32 v[96:97], v[96:97], v[148:149] op_sel_hi:[1,0] neg_lo:[0,1] neg_hi:[0,1]
    v_pk_add_f32 v[98:99], v[98:99], v[148:149] op_sel_hi:[1,0] neg_lo:[0,1] neg_hi:[0,1]
    v_pk_add_f32 v[100:101], v[100:101], v[148:149] op_sel_hi:[1,0] neg_lo:[0,1] neg_hi:[0,1]
    v_pk_add_f32 v[102:103], v[102:103], v[148:149] op_sel_hi:[1,0] neg_lo:[0,1] neg_hi:[0,1]
    v_pk_add_f32 v[104:105], v[104:105], v[148:149] op_sel_hi:[1,0] neg_lo:[0,1] neg_hi:[0,1]
    v_pk_add_f32 v[106:107], v[106:107], v[148:149] op_sel_hi:[1,0] neg_lo:[0,1] neg_hi:[0,1]
    v_pk_add_f32 v[108:109], v[108:109], v[148:149] op_sel_hi:[1,0] neg_lo:[0,1] neg_hi:[0,1]
    v_pk_add_f32 v[110:111], v[110:111], v[148:149] op_sel_hi:[1,0] neg_lo:[0,1] neg_hi:[0,1]
    v_pk_mul_f32 v[144:145], v[96:97], v[96:97]
    v_pk_mul_f32 v[146:147], v[98:99], v[98:99]
    v_pk_fma_f32 v[144:145], v[100:101], v[100:101], v[144:145]
    v_pk_fma_f32 v[146:147], v[102:103], v[102:103], v[146:147]
    v_pk_fma_f32 v[144:145], v[104:105], v[104:105], v[144:145]
    v_pk_fma_f32 v[146:147], v[106:107], v[106:107], v[146:147]
    v_pk_fma_f32 v[144:145], v[108:109], v[108:109], v[144:145]
    v_pk_fma_f32 v[146:147], v[110:111], v[110:111], v[146:147]
    v_pk_add_f32 v[146:147], v[144:145], v[146:147]
    v_add_f32 v146, v146, v147
    s_nop 1
    v_add_f32_dpp v146, v146, v146 row_ror:8 row_mask:0xf bank_mask:0xf
    s_nop 1
    v_add_f32_dpp v146, v146, v146 row_ror:4 row_mask:0xf bank_mask:0xf
    s_nop 1
    v_add_f32_dpp v146, v146, v146 row_ror:2 row_mask:0xf bank_mask:0xf
    s_nop 1
    v_add_f32_dpp v146, v146, v146 row_ror:1 row_mask:0xf bank_mask:0xf
    v_mov_b32 v147, v146
    s_nop 1
    v_permlane16_swap_b32 v146, v147
    v_add_f32 v146, v146, v147
    v_mul_f32 v150, 0x3b000000, v146
    v_cmp_eq_u32 vcc, 0, v5
    v_lshlrev_b32 v2, 4, v6
    v_mov_b32 v1, 2130706432
    v_cndmask_b32 v2, v1, v2, vcc
    s_lshl_b32 s48, s42, 4
    s_add_u32 s48, s48, s43
    s_lshl_b32 s48, s48, 2
    s_add_u32 s48, s48, s3
    s_lshl_b32 s48, s48, 5
    s_add_u32 s48, s48, 32768
    buffer_store_dwordx4 v[148:151], v2, s[36:39], s48 offen sc1
    s_waitcnt lgkmcnt(0)
    s_barrier
    ds_read_b64_tr_b16 v[96:97], v23 offset:16384
    ds_read_b64_tr_b16 v[98:99], v23 offset:17408
    ds_read_b64_tr_b16 v[100:101], v23 offset:20480
    ds_read_b64_tr_b16 v[102:103], v23 offset:21504
    ds_read_b64_tr_b16 v[104:105], v23 offset:24576
    ds_read_b64_tr_b16 v[106:107], v23 offset:25600
    ds_read_b64_tr_b16 v[108:109], v23 offset:28672
    ds_read_b64_tr_b16 v[110:111], v23 offset:29696
    s_add_u32 s50, s46, 2
    s_and_b32 s50, s50, 7
    s_mul_i32 s51, s50, 229376
    s_add_u32 s51, s51, s56
    s_lshl_b32 s50, s50, 7
    s_add_u32 m0, s58, 65536
    s_add_u32 s50, s50, s55
    buffer_load_dwordx4 v11, s[4:7], s50 offen offset:0 lds
    s_bfe_u32 s48, s2, 0x20003
    s_lshl_b32 s48, s48, 4
    s_and_b32 s49, s2, 1
    s_lshl_b32 s49, s49, 3
    s_add_u32 s48, s48, s49
    buffer_load_dwordx4 v12, s[4:7], s50 offen offset:1024 lds
    s_waitcnt lgkmcnt(6)
    v_mfma_f32_16x16x32_bf16 v[92:95], v[88:91], v[96:99], 0
    s_and_b32 s49, s2, 32
    s_lshl_b32 s49, s49, 5
    s_add_u32 s48, s48, s49
    s_and_b32 s49, s2, 6
    s_lshl_b32 s49, s49, 7
    buffer_load_dwordx4 v13, s[4:7], s50 offen offset:2048 lds
    s_add_u32 s48, s48, s49
    s_lshl_b32 s49, s3, 1
    s_add_u32 s48, s48, s49
    s_mul_i32 s48, s48, 514
    s_lshr_b32 s49, s2, 6
    buffer_load_dwordx4 v14, s[4:7], s50 offen offset:3072 lds
    s_add_u32 m0, s58, 81920
    s_waitcnt lgkmcnt(4)
    v_mfma_f32_16x16x32_bf16 v[92:95], v[88:91], v[100:103], v[92:95]
    s_lshl_b32 s49, s49, 7
    s_add_u32 s48, s48, s49
    v_lshlrev_b32 v1, 1, v4
    buffer_load_ushort v60, v1, s[8:11], s48 offen offset:2
    buffer_load_ushort v64, v1, s[12:15], s48 offen offset:2
    buffer_load_dwordx4 v15, s[16:19], s51 offen offset:0 lds
    buffer_load_ushort v68, v1, s[8:11], s48 offen offset:516
    buffer_load_ushort v72, v1, s[12:15], s48 offen offset:516
    s_add_u32 s48, s48, 32896
    buffer_load_ushort v61, v1, s[8:11], s48 offen offset:2
    buffer_load_ushort v65, v1, s[12:15], s48 offen offset:2
    buffer_load_dwordx4 v16, s[16:19], s51 offen offset:1024 lds
    s_waitcnt lgkmcnt(2)
    v_mfma_f32_16x16x32_bf16 v[92:95], v[88:91], v[104:107], v[92:95]
    buffer_load_ushort v69, v1, s[8:11], s48 offen offset:516
    buffer_load_ushort v73, v1, s[12:15], s48 offen offset:516
    s_add_u32 s48, s48, 32896
    buffer_load_ushort v62, v1, s[8:11], s48 offen offset:2
    buffer_load_ushort v66, v1, s[12:15], s48 offen offset:2
    buffer_load_dwordx4 v17, s[16:19], s51 offen offset:2048 lds
    buffer_load_ushort v70, v1, s[8:11], s48 offen offset:516
    buffer_load_ushort v74, v1, s[12:15], s48 offen offset:516
    s_add_u32 s48, s48, 32896
    buffer_load_ushort v63, v1, s[8:11], s48 offen offset:2
    buffer_load_ushort v67, v1, s[12:15], s48 offen offset:2
    buffer_load_dwordx4 v18, s[16:19], s51 offen offset:3072 lds
    s_waitcnt lgkmcnt(0)
    v_mfma_f32_16x16x32_bf16 v[92:95], v[88:91], v[108:111], v[92:95]
    buffer_load_ushort v71, v1, s[8:11], s48 offen offset:516
    buffer_load_ushort v75, v1, s[12:15], s48 offen offset:516
    v_and_b32 v1, 19, v5
    v_and_b32 v2, 4, v5
    v_lshl_add_u32 v1, v2, 1, v1
    s_waitcnt vmcnt(25)
    s_barrier
    ds_read_b64_tr_b16 v[96:97], v23 offset:49152
    ds_read_b64_tr_b16 v[98:99], v23 offset:50176
    ds_read_b64_tr_b16 v[100:101], v23 offset:53248
    ds_read_b64_tr_b16 v[102:103], v23 offset:54272
    ds_read_b64_tr_b16 v[104:105], v23 offset:57344
    ds_read_b64_tr_b16 v[106:107], v23 offset:58368
    ds_read_b64_tr_b16 v[108:109], v23 offset:61440
    ds_read_b64_tr_b16 v[110:111], v23 offset:62464
    s_add_u32 s50, s46, 3
    s_and_b32 s50, s50, 7
    s_mul_i32 s51, s50, 229376
    s_add_u32 s51, s51, s56
    s_lshl_b32 s50, s50, 7
    s_add_u32 m0, s58, 98304
    s_add_u32 s50, s50, s55
    buffer_load_dwordx4 v11, s[4:7], s50 offen offset:0 lds
    v_and_b32 v2, 8, v5
    v_lshrrev_b32 v2, 1, v2
    v_add_u32 v77, v1, v2
    s_mul_i32 s48, s40, 896
    s_lshl_b32 s49, s41, 8
    buffer_load_dwordx4 v12, s[4:7], s50 offen offset:1024 lds
    s_waitcnt lgkmcnt(6)
    v_mfma_f32_16x16x32_bf16 v[92:95], v[88:91], v[96:99], v[92:95]
    s_add_u32 s48, s48, s49
    s_lshl_b32 s49, s3, 6
    s_add_u32 s48, s48, s49
    v_lshl_add_u32 v1, v77, 1, s48
    buffer_load_ushort v76, v1, s[24:27], 0 offen
    buffer_load_dwordx4 v13, s[4:7], s50 offen offset:2048 lds
    s_lshl_b32 s48, s41, 8
    s_add_u32 s49, s49, s48
    v_lshlrev_b32 v1, 4, v6
    buffer_load_dwordx4 v[78:81], v1, s[28:31], s49 offen
    buffer_load_dwordx4 v[82:85], v1, s[28:31], s49 offen offset:32
    buffer_load_dwordx4 v14, s[4:7], s50 offen offset:3072 lds
    s_add_u32 m0, s58, 114688
    s_waitcnt lgkmcnt(4)
    v_mfma_f32_16x16x32_bf16 v[92:95], v[88:91], v[100:103], v[92:95]
    s_and_b32 s48, s42, 7
    s_lshl_b32 s48, s48, 2
    s_add_u32 s48, s48, s3
    s_mul_i32 s48, s48, 14336
    s_add_u32 s48, s48, s57
    buffer_load_dwordx4 v15, s[16:19], s51 offen offset:0 lds
    v_min_u32 v1, 13, v5
    v_lshlrev_b32 v1, 10, v1
    v_lshl_add_u32 v1, v6, 7, v1
    buffer_load_dword v86, v1, s[20:23], s48 offen
    s_lshl_b32 s48, s2, 2
    buffer_load_dwordx4 v16, s[16:19], s51 offen offset:1024 lds
    s_waitcnt lgkmcnt(2)
    v_mfma_f32_16x16x32_bf16 v[92:95], v[88:91], v[104:107], v[92:95]
    s_add_u32 s48, s48, s3
    s_lshl_b32 s48, s48, 7
    s_add_u32 s48, s48, 22478848
    v_lshlrev_b32 v1, 17, v7
    buffer_load_dword v86, v1, s[36:39], s48 offen sc1
    buffer_load_dwordx4 v17, s[16:19], s51 offen offset:2048 lds
    buffer_load_dwordx4 v18, s[16:19], s51 offen offset:3072 lds
    s_waitcnt lgkmcnt(0)
    v_mfma_f32_16x16x32_bf16 v[92:95], v[88:91], v[108:111], v[92:95]
    s_waitcnt vmcnt(15)
    s_barrier
    v_xor_b32 v23, 0x10000, v23
    ds_read_b64_tr_b16 v[96:97], v23 offset:16384
    ds_read_b64_tr_b16 v[98:99], v23 offset:17408
    ds_read_b64_tr_b16 v[100:101], v23 offset:20480
    ds_read_b64_tr_b16 v[102:103], v23 offset:21504
    ds_read_b64_tr_b16 v[104:105], v23 offset:24576
    ds_read_b64_tr_b16 v[106:107], v23 offset:25600
    ds_read_b64_tr_b16 v[108:109], v23 offset:28672
    ds_read_b64_tr_b16 v[110:111], v23 offset:29696
    s_add_u32 s50, s46, 4
    s_and_b32 s50, s50, 7
    s_mul_i32 s51, s50, 229376
    s_add_u32 s51, s51, s56
    s_lshl_b32 s50, s50, 7
    s_add_u32 m0, s58, 0
    s_add_u32 s50, s50, s55
    buffer_load_dwordx4 v11, s[4:7], s50 offen offset:0 lds
    buffer_load_dwordx4 v12, s[4:7], s50 offen offset:1024 lds
    s_waitcnt lgkmcnt(6)
    v_mfma_f32_16x16x32_bf16 v[92:95], v[88:91], v[96:99], v[92:95]
    buffer_load_dwordx4 v13, s[4:7], s50 offen offset:2048 lds
    buffer_load_dwordx4 v14, s[4:7], s50 offen offset:3072 lds
    s_add_u32 m0, s58, 16384
    s_waitcnt lgkmcnt(4)
    v_mfma_f32_16x16x32_bf16 v[92:95], v[88:91], v[100:103], v[92:95]
    buffer_load_dwordx4 v15, s[16:19], s51 offen offset:0 lds
    buffer_load_dwordx4 v16, s[16:19], s51 offen offset:1024 lds
    s_waitcnt lgkmcnt(2)
    v_mfma_f32_16x16x32_bf16 v[92:95], v[88:91], v[104:107], v[92:95]
    buffer_load_dwordx4 v17, s[16:19], s51 offen offset:2048 lds
    buffer_load_dwordx4 v18, s[16:19], s51 offen offset:3072 lds
    s_waitcnt lgkmcnt(0)
    v_mfma_f32_16x16x32_bf16 v[92:95], v[88:91], v[108:111], v[92:95]
    s_waitcnt vmcnt(8)
    s_barrier
    ds_read_b64_tr_b16 v[96:97], v23 offset:49152
    ds_read_b64_tr_b16 v[98:99], v23 offset:50176
    ds_read_b64_tr_b16 v[100:101], v23 offset:53248
    ds_read_b64_tr_b16 v[102:103], v23 offset:54272
    ds_read_b64_tr_b16 v[104:105], v23 offset:57344
    ds_read_b64_tr_b16 v[106:107], v23 offset:58368
    ds_read_b64_tr_b16 v[108:109], v23 offset:61440
    ds_read_b64_tr_b16 v[110:111], v23 offset:62464
    s_waitcnt vmcnt(21)
    v_lshl_or_b32 v24, v61, 16, v60
    v_lshl_or_b32 v25, v63, 16, v62
    v_lshl_or_b32 v26, v65, 16, v64
    v_lshl_or_b32 v27, v67, 16, v66
    v_lshl_or_b32 v28, v69, 16, v68
    v_lshl_or_b32 v29, v71, 16, v70
    v_lshl_or_b32 v30, v73, 16, v72
    v_lshl_or_b32 v31, v75, 16, v74
    s_lshl_b32 s48, s3, 1
    v_and_b32 v1, 7, v4
    v_xor_b32 v1, s48, v1
    v_lshlrev_b32 v1, 4, v1
    v_lshl_add_u32 v1, v4, 7, v1
    v_add_u32 v1, 139264, v1
    v_xor_b32 v2, 16, v1
    ds_write_b128 v1, v[24:27]
    ds_write_b128 v2, v[28:31]
    s_add_u32 s50, s46, 5
    s_and_b32 s50, s50, 7
    s_mul_i32 s51, s50, 229376
    s_add_u32 s51, s51, s56
    s_lshl_b32 s50, s50, 7
    s_add_u32 m0, s58, 32768
    s_add_u32 s50, s50, s55
    buffer_load_dwordx4 v11, s[4:7], s50 offen offset:0 lds
    buffer_load_dwordx4 v12, s[4:7], s50 offen offset:1024 lds
    s_waitcnt lgkmcnt(8)
    v_mfma_f32_16x16x32_bf16 v[92:95], v[88:91], v[96:99], v[92:95]
    buffer_load_dwordx4 v13, s[4:7], s50 offen offset:2048 lds
    buffer_load_dwordx4 v14, s[4:7], s50 offen offset:3072 lds
    s_add_u32 m0, s58, 49152
    s_waitcnt lgkmcnt(6)
    v_mfma_f32_16x16x32_bf16 v[92:95], v[88:91], v[100:103], v[92:95]
    buffer_load_dwordx4 v15, s[16:19], s51 offen offset:0 lds
    buffer_load_dwordx4 v16, s[16:19], s51 offen offset:1024 lds
    s_waitcnt lgkmcnt(4)
    v_mfma_f32_16x16x32_bf16 v[92:95], v[88:91], v[104:107], v[92:95]
    buffer_load_dwordx4 v17, s[16:19], s51 offen offset:2048 lds
    buffer_load_dwordx4 v18, s[16:19], s51 offen offset:3072 lds
    s_waitcnt lgkmcnt(2)
    v_mfma_f32_16x16x32_bf16 v[92:95], v[88:91], v[108:111], v[92:95]
    s_waitcnt lgkmcnt(0)
    s_waitcnt vmcnt(8)
    s_barrier
    v_xor_b32 v23, 0x10000, v23
    ds_read_b64_tr_b16 v[96:97], v23 offset:16384
    ds_read_b64_tr_b16 v[98:99], v23 offset:17408
    ds_read_b64_tr_b16 v[100:101], v23 offset:20480
    ds_read_b64_tr_b16 v[102:103], v23 offset:21504
    ds_read_b64_tr_b16 v[104:105], v23 offset:24576
    ds_read_b64_tr_b16 v[106:107], v23 offset:25600
    ds_read_b64_tr_b16 v[108:109], v23 offset:28672
    ds_read_b64_tr_b16 v[110:111], v23 offset:29696
    v_lshrrev_b32 v1, 3, v4
    v_lshlrev_b32 v2, 4, v1
    v_xor_b32 v2, v2, v9
    s_lshl_b32 s48, s3, 11
    s_add_u32 s48, s48, 139264
    v_add_u32 v2, s48, v2
    ds_read_b128 v[60:63], v2
    ds_read_b128 v[64:67], v2 offset:1024
    v_mul_u32_u24 v155, 8192, v1
    v_add_u32 v155, v155, v9
    s_lshr_b32 s48, s2, 6
    s_lshl_b32 s48, s48, 2
    s_add_u32 s48, s48, s3
    s_mul_i32 s48, s48, 133120
    s_and_b32 s49, s2, 63
    s_lshl_b32 s49, s49, 7
    s_add_u32 s48, s48, s49
    s_add_u32 s48, s48, 2424832
    s_add_u32 s49, s48, 66560
    s_waitcnt lgkmcnt(0)
    buffer_store_dwordx4 v[60:63], v155, s[36:39], s48 offen sc1
    buffer_store_dwordx4 v[64:67], v155, s[36:39], s49 offen sc1
    s_add_u32 s50, s46, 6
    s_and_b32 s50, s50, 7
    s_mul_i32 s51, s50, 229376
    s_add_u32 s51, s51, s56
    s_lshl_b32 s50, s50, 7
    s_add_u32 m0, s58, 65536
    s_add_u32 s50, s50, s55
    buffer_load_dwordx4 v11, s[4:7], s50 offen offset:0 lds
    buffer_load_dwordx4 v12, s[4:7], s50 offen offset:1024 lds
    s_waitcnt lgkmcnt(8)
    v_mfma_f32_16x16x32_bf16 v[92:95], v[88:91], v[96:99], v[92:95]
    buffer_load_dwordx4 v13, s[4:7], s50 offen offset:2048 lds
    buffer_load_dwordx4 v14, s[4:7], s50 offen offset:3072 lds
    s_add_u32 m0, s58, 81920
    s_waitcnt lgkmcnt(6)
    v_mfma_f32_16x16x32_bf16 v[92:95], v[88:91], v[100:103], v[92:95]
    buffer_load_dwordx4 v15, s[16:19], s51 offen offset:0 lds
    buffer_load_dwordx4 v16, s[16:19], s51 offen offset:1024 lds
    s_waitcnt lgkmcnt(4)
    v_mfma_f32_16x16x32_bf16 v[92:95], v[88:91], v[104:107], v[92:95]
    buffer_load_dwordx4 v17, s[16:19], s51 offen offset:2048 lds
    buffer_load_dwordx4 v18, s[16:19], s51 offen offset:3072 lds
    s_waitcnt lgkmcnt(2)
    v_mfma_f32_16x16x32_bf16 v[92:95], v[88:91], v[108:111], v[92:95]
    s_waitcnt vmcnt(10)
    s_barrier
    ds_read_b64_tr_b16 v[96:97], v23 offset:49152
    ds_read_b64_tr_b16 v[98:99], v23 offset:50176
    ds_read_b64_tr_b16 v[100:101], v23 offset:53248
    ds_read_b64_tr_b16 v[102:103], v23 offset:54272
    ds_read_b64_tr_b16 v[104:105], v23 offset:57344
    ds_read_b64_tr_b16 v[106:107], v23 offset:58368
    ds_read_b64_tr_b16 v[108:109], v23 offset:61440
    ds_read_b64_tr_b16 v[110:111], v23 offset:62464
    s_add_u32 s50, s46, 7
    s_and_b32 s50, s50, 7
    s_mul_i32 s51, s50, 229376
    s_add_u32 s51, s51, s56
    s_lshl_b32 s50, s50, 7
    s_add_u32 m0, s58, 98304
    s_add_u32 s50, s50, s55
    buffer_load_dwordx4 v11, s[4:7], s50 offen offset:0 lds
    buffer_load_dwordx4 v12, s[4:7], s50 offen offset:1024 lds
    s_waitcnt lgkmcnt(6)
    v_mfma_f32_16x16x32_bf16 v[92:95], v[88:91], v[96:99], v[92:95]
    buffer_load_dwordx4 v13, s[4:7], s50 offen offset:2048 lds
    buffer_load_dwordx4 v14, s[4:7], s50 offen offset:3072 lds
    s_add_u32 m0, s58, 114688
    s_waitcnt lgkmcnt(4)
    v_mfma_f32_16x16x32_bf16 v[92:95], v[88:91], v[100:103], v[92:95]
    buffer_load_dwordx4 v15, s[16:19], s51 offen offset:0 lds
    buffer_load_dwordx4 v16, s[16:19], s51 offen offset:1024 lds
    s_waitcnt lgkmcnt(2)
    v_mfma_f32_16x16x32_bf16 v[92:95], v[88:91], v[104:107], v[92:95]
    buffer_load_dwordx4 v17, s[16:19], s51 offen offset:2048 lds
    buffer_load_dwordx4 v18, s[16:19], s51 offen offset:3072 lds
    s_waitcnt lgkmcnt(0)
    v_mfma_f32_16x16x32_bf16 v[92:95], v[88:91], v[108:111], v[92:95]
    s_waitcnt vmcnt(8)
    s_lshr_b32 s48, s2, 6
    s_lshl_b32 s48, s48, 2
    s_add_u32 s48, s48, s3
    s_lshl_b32 s48, s48, 6
    s_and_b32 s49, s2, 63
    s_add_u32 s48, s48, s49
    s_lshl_b32 s48, s48, 2
    s_add_u32 s48, s48, 4096
    s_waitcnt vmcnt(16)
    buffer_store_dword v87, v10, s[36:39], s48 offen sc1
    s_barrier
    v_xor_b32 v23, 0x10000, v23
    ds_read_b64_tr_b16 v[96:97], v23 offset:16384
    ds_read_b64_tr_b16 v[98:99], v23 offset:17408
    ds_read_b64_tr_b16 v[100:101], v23 offset:20480
    ds_read_b64_tr_b16 v[102:103], v23 offset:21504
    ds_read_b64_tr_b16 v[104:105], v23 offset:24576
    ds_read_b64_tr_b16 v[106:107], v23 offset:25600
    ds_read_b64_tr_b16 v[108:109], v23 offset:28672
    ds_read_b64_tr_b16 v[110:111], v23 offset:29696
    s_bfe_u32 s50, s47, 196608
    s_lshl_b32 s50, s50, 2
    s_add_u32 s50, s50, s3
    s_lshl_b32 s50, s50, 14
    s_add_u32 m0, s58, 147456
    s_add_u32 s50, s50, s57
    buffer_load_dwordx4 v19, s[20:23], s50 offen offset:0 lds
    buffer_load_dwordx4 v20, s[20:23], s50 offen offset:1024 lds
    s_waitcnt lgkmcnt(6)
    v_mfma_f32_16x16x32_bf16 v[92:95], v[88:91], v[96:99], v[92:95]
    buffer_load_dwordx4 v21, s[20:23], s50 offen offset:2048 lds
    buffer_load_dwordx4 v22, s[20:23], s50 offen offset:3072 lds
    s_waitcnt lgkmcnt(4)
    v_mfma_f32_16x16x32_bf16 v[92:95], v[88:91], v[100:103], v[92:95]
    s_bfe_u32 s50, s47, 196612
    s_lshl_b32 s50, s50, 2
    s_add_u32 s50, s50, s3
    s_lshl_b32 s50, s50, 14
    s_add_u32 m0, s58, 0
    s_add_u32 s50, s50, s57
    buffer_load_dwordx4 v19, s[20:23], s50 offen offset:0 lds
    buffer_load_dwordx4 v20, s[20:23], s50 offen offset:1024 lds
    s_waitcnt lgkmcnt(2)
    v_mfma_f32_16x16x32_bf16 v[92:95], v[88:91], v[104:107], v[92:95]
    buffer_load_dwordx4 v21, s[20:23], s50 offen offset:2048 lds
    buffer_load_dwordx4 v22, s[20:23], s50 offen offset:3072 lds
    s_waitcnt lgkmcnt(0)
    v_mfma_f32_16x16x32_bf16 v[92:95], v[88:91], v[108:111], v[92:95]
    s_waitcnt vmcnt(9)
    s_barrier
    ds_read_b64_tr_b16 v[96:97], v23 offset:49152
    ds_read_b64_tr_b16 v[98:99], v23 offset:50176
    ds_read_b64_tr_b16 v[100:101], v23 offset:53248
    ds_read_b64_tr_b16 v[102:103], v23 offset:54272
    ds_read_b64_tr_b16 v[104:105], v23 offset:57344
    ds_read_b64_tr_b16 v[106:107], v23 offset:58368
    ds_read_b64_tr_b16 v[108:109], v23 offset:61440
    ds_read_b64_tr_b16 v[110:111], v23 offset:62464
    s_bfe_u32 s50, s47, 196616
    s_lshl_b32 s50, s50, 2
    s_add_u32 s50, s50, s3
    s_lshl_b32 s50, s50, 14
    s_add_u32 m0, s58, 16384
    s_add_u32 s50, s50, s57
    buffer_load_dwordx4 v19, s[20:23], s50 offen offset:0 lds
    buffer_load_dwordx4 v20, s[20:23], s50 offen offset:1024 lds
    s_waitcnt lgkmcnt(6)
    v_mfma_f32_16x16x32_bf16 v[92:95], v[88:91], v[96:99], v[92:95]
    s_waitcnt lgkmcnt(4)
    v_mfma_f32_16x16x32_bf16 v[92:95], v[88:91], v[100:103], v[92:95]
    s_waitcnt lgkmcnt(2)
    v_mfma_f32_16x16x32_bf16 v[92:95], v[88:91], v[104:107], v[92:95]
    s_waitcnt lgkmcnt(0)
    v_mfma_f32_16x16x32_bf16 v[92:95], v[88:91], v[108:111], v[92:95]
    s_lshl_b32 s48, s3, 9
    s_add_u32 s48, s48, 131072
    v_add_u32 v39, s48, v37
    v_lshl_or_b32 v76, v76, 16, v76
    s_nop 3
    v_and_b32 v1, 0xffff0000, v92
    v_sub_f32 v2, v92, v1
    v_cvt_pk_bf16_f32 v92, v1, v2
    v_mov_b32 v93, v92
    v_mov_b32 v94, v76
    v_mov_b32 v95, 0
    ds_write_b128 v39, v[92:95]
    buffer_load_dwordx4 v21, s[20:23], s50 offen offset:2048 lds
    buffer_load_dwordx4 v22, s[20:23], s50 offen offset:3072 lds
    s_bfe_u32 s50, s47, 196620
    s_lshl_b32 s50, s50, 2
    s_add_u32 s50, s50, s3
    s_lshl_b32 s50, s50, 14
    s_add_u32 m0, s58, 32768
    s_add_u32 s50, s50, s57
    buffer_load_dwordx4 v19, s[20:23], s50 offen offset:0 lds
    s_waitcnt lgkmcnt(0)
    s_barrier
    buffer_load_dwordx4 v20, s[20:23], s50 offen offset:1024 lds
    buffer_load_dwordx4 v21, s[20:23], s50 offen offset:2048 lds
    buffer_load_dwordx4 v22, s[20:23], s50 offen offset:3072 lds
    s_lshl_b32 s48, s3, 13
    s_add_u32 s48, s48, 98304
    v_add_u32 v32, s48, v9
    s_lshl_b32 s48, s3, 1
    s_and_b32 s49, s3, 1
    s_add_u32 s48, s48, s49
    s_lshl_b32 s48, s48, 11
    s_add_u32 s48, s48, 98304
    v_add_u32 v1, s48, v9
    s_mul_i32 s48, s43, 133120
    s_lshl_b32 s49, s42, 8
    s_add_u32 s48, s48, s49
    s_lshr_b32 s49, s3, 1
    s_lshl_b32 s49, s49, 12
    s_add_u32 s48, s48, s49
    s_and_b32 s49, s3, 1
    s_lshl_b32 s49, s49, 7
    s_add_u32 s48, s48, s49
    s_add_u32 s48, s48, 262144
    s_add_u32 s49, s48, 66560
    s_barrier
    ds_read_b128 v[96:99], v1
    ds_read_b128 v[100:103], v1 offset:1024
    s_waitcnt lgkmcnt(0)
    buffer_store_dwordx4 v[96:99], v155, s[36:39], s48 offen sc1
    buffer_store_dwordx4 v[100:103], v155, s[36:39], s49 offen sc1
    v_lshlrev_b32 v56, 2, v4
    s_lshr_b32 s51, s2, 4
    s_lshl_b32 s51, s51, 8
    s_add_u32 s51, s51, 4096
    buffer_load_dword v33, v56, s[36:39], s51 offen sc1
    s_bfe_u32 s50, s47, 196624
    s_lshl_b32 s50, s50, 2
    s_add_u32 s50, s50, s3
    s_lshl_b32 s50, s50, 14
    s_add_u32 m0, s58, 49152
    s_add_u32 s50, s50, s57
    buffer_load_dwordx4 v19, s[20:23], s50 offen offset:0 lds
    buffer_load_dwordx4 v20, s[20:23], s50 offen offset:1024 lds
    buffer_load_dwordx4 v21, s[20:23], s50 offen offset:2048 lds
    buffer_load_dwordx4 v22, s[20:23], s50 offen offset:3072 lds
    s_bfe_u32 s50, s47, 196628
    s_lshl_b32 s50, s50, 2
    s_add_u32 s50, s50, s3
    s_lshl_b32 s50, s50, 14
    s_add_u32 m0, s58, 65536
    s_add_u32 s50, s50, s57
    buffer_load_dwordx4 v19, s[20:23], s50 offen offset:0 lds
    buffer_load_dwordx4 v20, s[20:23], s50 offen offset:1024 lds
    buffer_load_dwordx4 v21, s[20:23], s50 offen offset:2048 lds
    buffer_load_dwordx4 v22, s[20:23], s50 offen offset:3072 lds
    s_bfe_u32 s50, s47, 196632
    s_lshl_b32 s50, s50, 2
    s_add_u32 s50, s50, s3
    s_lshl_b32 s50, s50, 14
    s_add_u32 m0, s58, 81920
    s_add_u32 s50, s50, s57
    buffer_load_dwordx4 v19, s[20:23], s50 offen offset:0 lds
    buffer_load_dwordx4 v20, s[20:23], s50 offen offset:1024 lds
    buffer_load_dwordx4 v21, s[20:23], s50 offen offset:2048 lds
    buffer_load_dwordx4 v22, s[20:23], s50 offen offset:3072 lds
    s_lshl_b32 s48, s43, 4
    s_add_u32 s48, s48, s42
    s_lshl_b32 s48, s48, 2
    s_add_u32 s48, s48, s3
    s_lshl_b32 s48, s48, 7
    s_add_u32 s48, s48, 22478848
    s_waitcnt vmcnt(13)
    buffer_store_dword v87, v10, s[36:39], s48 offen sc1
    ds_write_b32 v38, v38 offset:0
    s_mov_b32 s45, 65536
    s_waitcnt vmcnt(13)
POLL_15:
    v_xor_b32 v1, s44, v33
    v_cmp_ne_u32 vcc, 0, v1
    s_sub_u32 s45, s45, 1
    s_cbranch_scc1 PDONE_16
    s_cbranch_vccz PDONE_16
    s_mov_b64 exec, vcc
    buffer_load_dword v33, v56, s[36:39], s51 offen sc1
    s_waitcnt vmcnt(0)
    s_branch POLL_15
PDONE_16:
    s_mov_b64 exec, -1
    s_mul_i32 s48, s2, 8320
    s_lshl_b32 s49, s3, 10
    s_add_u32 s48, s48, s49
    s_add_u32 s49, s48, 2424832
    s_add_u32 s50, s49, 4096
    buffer_load_dwordx4 v[16:19], v9, s[36:39], s49 offen sc1
    buffer_load_dwordx4 v[20:23], v9, s[36:39], s50 offen sc1
    v_lshlrev_b32 v39, 7, v8
    s_lshr_b32 s51, s2, 4
    s_lshl_b32 s51, s51, 2
    s_add_u32 s51, s51, s3
    s_lshl_b32 s51, s51, 11
    s_add_u32 s51, s51, 22478848
    buffer_load_dword v12, v39, s[36:39], s51 offen sc1
    s_waitcnt vmcnt(0)
    ds_write_b32 v38, v38 offset:16
    s_mov_b32 s45, 65536
    s_waitcnt vmcnt(0)
POLL_17:
    v_xor_b32 v1, s44, v12
    v_cmp_ne_u32 vcc, 0, v1
    s_sub_u32 s45, s45, 1
    s_cbranch_scc1 PDONE_18
    s_cbranch_vccz PDONE_18
    s_mov_b64 exec, vcc
    buffer_load_dword v12, v39, s[36:39], s51 offen sc1
    s_waitcnt vmcnt(0)
    s_branch POLL_17
PDONE_18:
    s_mov_b64 exec, -1
    s_add_u32 s49, s48, 262144
    s_add_u32 s50, s49, 4096
    buffer_load_dwordx4 v[212:215], v9, s[36:39], s49 offen sc1
    buffer_load_dwordx4 v[216:219], v9, s[36:39], s50 offen sc1
    v_lshlrev_b32 v40, 16, v16
    v_and_b32 v41, 0xffff0000, v16
    v_lshlrev_b32 v42, 16, v17
    v_and_b32 v43, 0xffff0000, v17
    v_lshlrev_b32 v48, 16, v18
    v_and_b32 v49, 0xffff0000, v18
    v_lshlrev_b32 v50, 16, v19
    v_and_b32 v51, 0xffff0000, v19
    v_lshlrev_b32 v44, 16, v20
    v_and_b32 v45, 0xffff0000, v20
    v_lshlrev_b32 v46, 16, v21
    v_and_b32 v47, 0xffff0000, v21
    v_lshlrev_b32 v52, 16, v22
    v_and_b32 v53, 0xffff0000, v22
    v_lshlrev_b32 v54, 16, v23
    v_and_b32 v55, 0xffff0000, v23
    v_add_u32 v39, 100352, v9
    s_waitcnt vmcnt(1)
    ds_write_b128 v32, v[212:215] offset:4096
    s_waitcnt vmcnt(0)
    ds_write_b128 v32, v[216:219] offset:5120
    ds_write_b32 v38, v38 offset:80
    s_mov_b32 s45, 1048576
LW_19:
    ds_read_b128 v[104:107], v36 offset:80
    s_waitcnt lgkmcnt(0)
    v_min_u32 v104, v104, v105
    v_min3_u32 v104, v104, v106, v107
    v_cmp_eq_u32 vcc, 0, v104
    s_sub_u32 s45, s45, 1
    s_cbranch_scc1 LD_20
    s_cbranch_vccnz LW_19
LD_20:
    ds_read_b128 v[212:215], v39 offset:2048
    ds_read_b128 v[228:231], v39 offset:3072
    ds_read_b128 v[216:219], v39 offset:10240
    ds_read_b128 v[232:235], v39 offset:11264
    ds_read_b128 v[220:223], v39 offset:18432
    ds_read_b128 v[236:239], v39 offset:19456
    ds_read_b128 v[224:227], v39 offset:26624
    ds_read_b128 v[240:243], v39 offset:27648
    s_waitcnt lgkmcnt(6)
    v_mfma_f32_16x16x32_bf16 v[24:27], v[212:215], v[112:115], 0
    v_mfma_f32_16x16x32_bf16 v[60:63], v[212:215], v[128:131], 0
    v_mfma_f32_16x16x32_bf16 v[28:31], v[228:231], v[112:115], 0
    v_mfma_f32_16x16x32_bf16 v[64:67], v[228:231], v[128:131], 0
    s_waitcnt lgkmcnt(4)
    v_mfma_f32_16x16x32_bf16 v[24:27], v[216:219], v[116:119], v[24:27]
    v_mfma_f32_16x16x32_bf16 v[60:63], v[216:219], v[132:135], v[60:63]
    v_mfma_f32_16x16x32_bf16 v[28:31], v[232:235], v[116:119], v[28:31]
    v_mfma_f32_16x16x32_bf16 v[64:67], v[232:235], v[132:135], v[64:67]
    s_waitcnt lgkmcnt(2)
    v_mfma_f32_16x16x32_bf16 v[24:27], v[220:223], v[120:123], v[24:27]
    v_mfma_f32_16x16x32_bf16 v[60:63], v[220:223], v[136:139], v[60:63]
    v_mfma_f32_16x16x32_bf16 v[28:31], v[236:239], v[120:123], v[28:31]
    v_mfma_f32_16x16x32_bf16 v[64:67], v[236:239], v[136:139], v[64:67]
    s_waitcnt lgkmcnt(0)
    v_mfma_f32_16x16x32_bf16 v[24:27], v[224:227], v[124:127], v[24:27]
    v_mfma_f32_16x16x32_bf16 v[60:63], v[224:227], v[140:143], v[60:63]
    v_mfma_f32_16x16x32_bf16 v[28:31], v[240:243], v[124:127], v[28:31]
    v_mfma_f32_16x16x32_bf16 v[64:67], v[240:243], v[140:143], v[64:67]
    s_nop 4
    v_mul_f32 v68, v24, v180
    v_mul_f32 v88, v60, v180
    v_mul_f32 v69, v25, v181
    v_mul_f32 v89, v61, v181
    v_mul_f32 v70, v26, v182
    v_mul_f32 v90, v62, v182
    v_mul_f32 v71, v27, v183
    v_mul_f32 v91, v63, v183
    v_mul_f32 v72, v28, v184
    v_mul_f32 v92, v64, v184
    v_mul_f32 v73, v29, v185
    v_mul_f32 v93, v65, v185
    v_mul_f32 v74, v30, v186
    v_mul_f32 v94, v66, v186
    v_mul_f32 v75, v31, v187
    v_mul_f32 v95, v67, v187
    v_fma_f32 v68, v60, v188, v68
    v_fma_f32 v88, -v24, v188, v88
    v_fma_f32 v69, v61, v189, v69
    v_fma_f32 v89, -v25, v189, v89
    v_fma_f32 v70, v62, v190, v70
    v_fma_f32 v90, -v26, v190, v90
    v_fma_f32 v71, v63, v191, v71
    v_fma_f32 v91, -v27, v191, v91
    v_fma_f32 v72, v64, v192, v72
    v_fma_f32 v92, -v28, v192, v92
    v_fma_f32 v73, v65, v193, v73
    v_fma_f32 v93, -v29, v193, v93
    v_fma_f32 v74, v66, v194, v74
    v_fma_f32 v94, -v30, v194, v94
    v_fma_f32 v75, v67, v195, v75
    v_fma_f32 v95, -v31, v195, v95
    v_cvt_pk_bf16_f32 v96, v68, v69
    v_cvt_pk_bf16_f32 v100, v88, v89
    v_cvt_pk_bf16_f32 v97, v70, v71
    v_cvt_pk_bf16_f32 v101, v90, v91
    v_cvt_pk_bf16_f32 v98, v72, v73
    v_cvt_pk_bf16_f32 v102, v92, v93
    v_cvt_pk_bf16_f32 v99, v74, v75
    v_cvt_pk_bf16_f32 v103, v94, v95
    s_nop 0
    v_mfma_f32_16x16x32_bf16 v[24:27], v[156:159], v[96:99], 0
    v_mfma_f32_16x16x32_bf16 v[60:63], v[156:159], v[100:103], 0
    v_mfma_f32_16x16x32_bf16 v[28:31], v[160:163], v[96:99], 0
    v_mfma_f32_16x16x32_bf16 v[64:67], v[160:163], v[100:103], 0
    v_mfma_f32_16x16x32_bf16 v[24:27], v[164:167], v[100:103], v[24:27]
    v_mfma_f32_16x16x32_bf16 v[60:63], v[172:175], v[96:99], v[60:63]
    v_mfma_f32_16x16x32_bf16 v[28:31], v[168:171], v[100:103], v[28:31]
    v_mfma_f32_16x16x32_bf16 v[64:67], v[176:179], v[96:99], v[64:67]
    s_nop 4
    v_mul_f32 v68, v24, v40
    v_mul_f32 v88, v60, v40
    v_mul_f32 v69, v25, v41
    v_mul_f32 v89, v61, v41
    v_mul_f32 v70, v26, v42
    v_mul_f32 v90, v62, v42
    v_mul_f32 v71, v27, v43
    v_mul_f32 v91, v63, v43
    v_mul_f32 v72, v28, v44
    v_mul_f32 v92, v64, v44
    v_mul_f32 v73, v29, v45
    v_mul_f32 v93, v65, v45
    v_mul_f32 v74, v30, v46
    v_mul_f32 v94, v66, v46
    v_mul_f32 v75, v31, v47
    v_mul_f32 v95, v67, v47
    v_fma_f32 v68, -v60, v48, v68
    v_fma_f32 v88, v24, v48, v88
    v_fma_f32 v69, -v61, v49, v69
    v_fma_f32 v89, v25, v49, v89
    v_fma_f32 v70, -v62, v50, v70
    v_fma_f32 v90, v26, v50, v90
    v_fma_f32 v71, -v63, v51, v71
    v_fma_f32 v91, v27, v51, v91
    v_fma_f32 v72, -v64, v52, v72
    v_fma_f32 v92, v28, v52, v92
    v_fma_f32 v73, -v65, v53, v73
    v_fma_f32 v93, v29, v53, v93
    v_fma_f32 v74, -v66, v54, v74
    v_fma_f32 v94, v30, v54, v94
    v_fma_f32 v75, -v67, v55, v75
    v_fma_f32 v95, v31, v55, v95
    v_cvt_pk_bf16_f32 v96, v68, v69
    v_cvt_pk_bf16_f32 v100, v88, v89
    v_cvt_pk_bf16_f32 v97, v70, v71
    v_cvt_pk_bf16_f32 v101, v90, v91
    v_cvt_pk_bf16_f32 v98, v72, v73
    v_cvt_pk_bf16_f32 v102, v92, v93
    v_cvt_pk_bf16_f32 v99, v74, v75
    v_cvt_pk_bf16_f32 v103, v94, v95
    s_nop 0
    v_mfma_f32_16x16x32_bf16 v[24:27], v[96:99], v[156:159], 0
    v_mfma_f32_16x16x32_bf16 v[60:63], v[100:103], v[156:159], 0
    v_mfma_f32_16x16x32_bf16 v[28:31], v[96:99], v[160:163], 0
    v_mfma_f32_16x16x32_bf16 v[64:67], v[100:103], v[160:163], 0
    v_mfma_f32_16x16x32_bf16 v[24:27], v[100:103], v[172:175], v[24:27]
    v_mfma_f32_16x16x32_bf16 v[60:63], v[96:99], v[164:167], v[60:63]
    v_mfma_f32_16x16x32_bf16 v[28:31], v[100:103], v[176:179], v[28:31]
    v_mfma_f32_16x16x32_bf16 v[64:67], v[96:99], v[168:171], v[64:67]
    s_nop 4
    v_mul_f32 v68, v24, v196
    v_mul_f32 v88, v60, v196
    v_mul_f32 v69, v25, v197
    v_mul_f32 v89, v61, v197
    v_mul_f32 v70, v26, v198
    v_mul_f32 v90, v62, v198
    v_mul_f32 v71, v27, v199
    v_mul_f32 v91, v63, v199
    v_mul_f32 v72, v28, v200
    v_mul_f32 v92, v64, v200
    v_mul_f32 v73, v29, v201
    v_mul_f32 v93, v65, v201
    v_mul_f32 v74, v30, v202
    v_mul_f32 v94, v66, v202
    v_mul_f32 v75, v31, v203
    v_mul_f32 v95, v67, v203
    v_fma_f32 v68, -v60, v204, v68
    v_fma_f32 v88, v24, v204, v88
    v_fma_f32 v69, -v61, v205, v69
    v_fma_f32 v89, v25, v205, v89
    v_fma_f32 v70, -v62, v206, v70
    v_fma_f32 v90, v26, v206, v90
    v_fma_f32 v71, -v63, v207, v71
    v_fma_f32 v91, v27, v207, v91
    v_fma_f32 v72, -v64, v208, v72
    v_fma_f32 v92, v28, v208, v92
    v_fma_f32 v73, -v65, v209, v73
    v_fma_f32 v93, v29, v209, v93
    v_fma_f32 v74, -v66, v210, v74
    v_fma_f32 v94, v30, v210, v94
    v_fma_f32 v75, -v67, v211, v75
    v_fma_f32 v95, v31, v211, v95
    v_cvt_pk_bf16_f32 v96, v88, v68
    v_cvt_pk_bf16_f32 v97, v89, v69
    v_cvt_pk_bf16_f32 v98, v90, v70
    v_cvt_pk_bf16_f32 v99, v91, v71
    v_cvt_pk_bf16_f32 v100, v92, v72
    v_cvt_pk_bf16_f32 v101, v93, v73
    v_cvt_pk_bf16_f32 v102, v94, v74
    v_cvt_pk_bf16_f32 v103, v95, v75
    ds_write_b128 v32, v[96:99] offset:2048
    ds_write_b128 v32, v[100:103] offset:3072
    ds_write_b32 v38, v38 offset:32
    v_lshrrev_b32 v1, 3, v8
    v_lshl_add_u32 v1, v7, 2, v1
    v_mul_u32_u24 v56, 32896, v1
    v_and_b32 v1, 7, v8
    v_lshl_add_u32 v56, v1, 4, v56
    s_mul_i32 s48, s3, 526336
    s_lshl_b32 s49, s2, 7
    s_add_u32 s48, s48, s49
    s_add_u32 s48, s48, 4587520
    s_add_u32 s49, s48, 65792
    s_mov_b32 s45, 1048576
LW_21:
    ds_read_b128 v[104:107], v36 offset:32
    s_waitcnt lgkmcnt(0)
    v_min_u32 v104, v104, v105
    v_min3_u32 v104, v104, v106, v107
    v_cmp_eq_u32 vcc, 0, v104
    s_sub_u32 s45, s45, 1
    s_cbranch_scc1 LD_22
    s_cbranch_vccnz LW_21
LD_22:
    ds_read_b128 v[212:215], v39 offset:0
    ds_read_b128 v[228:231], v39 offset:1024
    ds_read_b128 v[216:219], v39 offset:8192
    ds_read_b128 v[232:235], v39 offset:9216
    ds_read_b128 v[220:223], v39 offset:16384
    ds_read_b128 v[236:239], v39 offset:17408
    ds_read_b128 v[224:227], v39 offset:24576
    ds_read_b128 v[240:243], v39 offset:25600
    s_waitcnt lgkmcnt(6)
    v_mfma_f32_16x16x32_bf16 v[24:27], v[112:115], v[212:215], 0
    v_mfma_f32_16x16x32_bf16 v[60:63], v[128:131], v[212:215], 0
    v_mfma_f32_16x16x32_bf16 v[28:31], v[112:115], v[228:231], 0
    v_mfma_f32_16x16x32_bf16 v[64:67], v[128:131], v[228:231], 0
    s_waitcnt lgkmcnt(4)
    v_mfma_f32_16x16x32_bf16 v[24:27], v[116:119], v[216:219], v[24:27]
    v_mfma_f32_16x16x32_bf16 v[60:63], v[132:135], v[216:219], v[60:63]
    v_mfma_f32_16x16x32_bf16 v[28:31], v[116:119], v[232:235], v[28:31]
    v_mfma_f32_16x16x32_bf16 v[64:67], v[132:135], v[232:235], v[64:67]
    s_waitcnt lgkmcnt(2)
    v_mfma_f32_16x16x32_bf16 v[24:27], v[120:123], v[220:223], v[24:27]
    v_mfma_f32_16x16x32_bf16 v[60:63], v[136:139], v[220:223], v[60:63]
    v_mfma_f32_16x16x32_bf16 v[28:31], v[120:123], v[236:239], v[28:31]
    v_mfma_f32_16x16x32_bf16 v[64:67], v[136:139], v[236:239], v[64:67]
    s_waitcnt lgkmcnt(0)
    v_mfma_f32_16x16x32_bf16 v[24:27], v[124:127], v[224:227], v[24:27]
    v_mfma_f32_16x16x32_bf16 v[60:63], v[140:143], v[224:227], v[60:63]
    v_mfma_f32_16x16x32_bf16 v[28:31], v[124:127], v[240:243], v[28:31]
    v_mfma_f32_16x16x32_bf16 v[64:67], v[140:143], v[240:243], v[64:67]
    ds_write_b32 v38, v38 offset:48
    s_nop 4
    v_cvt_pk_bf16_f32 v96, v60, v61
    v_cvt_pk_bf16_f32 v98, v24, v25
    v_cvt_pk_bf16_f32 v97, v62, v63
    v_cvt_pk_bf16_f32 v99, v26, v27
    v_cvt_pk_bf16_f32 v100, v64, v65
    v_cvt_pk_bf16_f32 v102, v28, v29
    v_cvt_pk_bf16_f32 v101, v66, v67
    v_cvt_pk_bf16_f32 v103, v30, v31
    buffer_store_dwordx4 v[96:99], v56, s[36:39], s48 offen sc1
    buffer_store_dwordx4 v[100:103], v56, s[36:39], s49 offen sc1
    v_bfe_u32 v1, v4, 2, 2
    v_lshl_add_u32 v1, v1, 5, v7
    v_lshlrev_b32 v1, 10, v1
    v_and_b32 v2, 3, v4
    v_lshl_add_u32 v11, v2, 4, v1
    s_lshl_b32 s48, s42, 17
    s_lshl_b32 s49, s40, 13
    s_add_u32 s48, s48, s49
    s_lshl_b32 s49, s41, 8
    s_lshl_b32 s50, s3, 6
    s_add_u32 s49, s49, s50
    s_add_u32 s61, s48, s49
    s_add_u32 s62, s61, 4096
    buffer_load_dwordx4 v[16:19], v11, s[4:7], s61 offen
    buffer_load_dwordx4 v[20:23], v11, s[4:7], s62 offen
    s_lshr_b32 s49, s49, 1
    v_add_u32 v39, s49, v77
    v_cvt_f32_u32 v39, v39
    v_mul_f32 v39, 0x3b000000, v39
    v_mul_f32 v58, 0x41000000, v39
    v_cos_f32 v58, v58
    v_lshlrev_b32 v1, 2, v6
    v_cvt_f32_u32 v1, v1
    v_mul_f32 v56, v1, v39
    v_add_f32 v57, 0x3e800000, v56
    v_add_f32 v58, v58, v58
    v_fmamk_f32 v40, v39, 0x3f800000, v56
    v_fmamk_f32 v48, v39, 0x41100000, v56
    v_fmamk_f32 v41, v39, 0x40000000, v56
    v_fmamk_f32 v49, v39, 0x41200000, v56
    v_fmamk_f32 v42, v39, 0x40400000, v57
    v_fmamk_f32 v50, v39, 0x41300000, v57
    v_fmamk_f32 v43, v39, 0x40800000, v57
    v_fmamk_f32 v51, v39, 0x41400000, v57
    v_fmamk_f32 v44, v39, 0x3f800000, v57
    v_fmamk_f32 v52, v39, 0x41100000, v57
    v_fmamk_f32 v45, v39, 0x40000000, v57
    v_fmamk_f32 v53, v39, 0x41200000, v57
    v_fmamk_f32 v46, v39, 0x40400000, v56
    v_fmamk_f32 v54, v39, 0x41300000, v56
    v_fmamk_f32 v47, v39, 0x40800000, v56
    v_fmamk_f32 v55, v39, 0x41400000, v56
    v_cos_f32 v40, v40
    v_cos_f32 v48, v48
    v_cos_f32 v41, v41
    v_cos_f32 v49, v49
    v_cos_f32 v42, v42
    v_cos_f32 v50, v50
    v_cos_f32 v43, v43
    v_cos_f32 v51, v51
    v_cos_f32 v44, v44
    v_cos_f32 v52, v52
    v_cos_f32 v45, v45
    v_cos_f32 v53, v53
    v_cos_f32 v46, v46
    v_cos_f32 v54, v54
    v_cos_f32 v47, v47
    v_cos_f32 v55, v55
    s_lshl_b32 s48, s3, 8
    s_add_u32 s48, s48, s2
    s_lshl_b32 s48, s48, 7
    s_add_u32 s48, s48, 22609920
    s_setprio 0
    v_cvt_pk_bf16_f32 v24, v40, v41
    v_cvt_pk_bf16_f32 v25, v42, v43
    v_cvt_pk_bf16_f32 v26, v44, v45
    v_cvt_pk_bf16_f32 v27, v46, v47
    v_fma_f32 v40, v48, v58, -v40
    v_fma_f32 v41, v49, v58, -v41
    v_fma_f32 v42, v50, v58, -v42
    v_fma_f32 v43, v51, v58, -v43
    v_fma_f32 v44, v52, v58, -v44
    v_fma_f32 v45, v53, v58, -v45
    v_fma_f32 v46, v54, v58, -v46
    v_fma_f32 v47, v55, v58, -v47
    v_cvt_pk_bf16_f32 v28, v48, v49
    v_cvt_pk_bf16_f32 v29, v50, v51
    v_cvt_pk_bf16_f32 v30, v52, v53
    v_cvt_pk_bf16_f32 v31, v54, v55
    v_fma_f32 v48, v40, v58, -v48
    v_fma_f32 v49, v41, v58, -v49
    v_fma_f32 v50, v42, v58, -v50
    v_fma_f32 v51, v43, v58, -v51
    v_fma_f32 v52, v44, v58, -v52
    v_fma_f32 v53, v45, v58, -v53
    v_fma_f32 v54, v46, v58, -v54
    v_fma_f32 v55, v47, v58, -v55
    v_cvt_pk_bf16_f32 v88, v40, v41
    v_cvt_pk_bf16_f32 v89, v42, v43
    v_cvt_pk_bf16_f32 v90, v44, v45
    v_cvt_pk_bf16_f32 v91, v46, v47
    v_fma_f32 v40, v48, v58, -v40
    v_fma_f32 v41, v49, v58, -v41
    v_fma_f32 v42, v50, v58, -v42
    v_fma_f32 v43, v51, v58, -v43
    v_fma_f32 v44, v52, v58, -v44
    v_fma_f32 v45, v53, v58, -v45
    v_fma_f32 v46, v54, v58, -v46
    v_fma_f32 v47, v55, v58, -v47
    v_cvt_pk_bf16_f32 v92, v48, v49
    v_cvt_pk_bf16_f32 v93, v50, v51
    v_cvt_pk_bf16_f32 v94, v52, v53
    v_cvt_pk_bf16_f32 v95, v54, v55
    v_fma_f32 v48, v40, v58, -v48
    v_fma_f32 v49, v41, v58, -v49
    v_fma_f32 v50, v42, v58, -v50
    v_fma_f32 v51, v43, v58, -v51
    v_fma_f32 v52, v44, v58, -v52
    v_fma_f32 v53, v45, v58, -v53
    v_fma_f32 v54, v46, v58, -v54
    v_fma_f32 v55, v47, v58, -v55
    v_cvt_pk_bf16_f32 v96, v40, v41
    v_cvt_pk_bf16_f32 v97, v42, v43
    v_cvt_pk_bf16_f32 v98, v44, v45
    v_cvt_pk_bf16_f32 v99, v46, v47
    v_fma_f32 v40, v48, v58, -v40
    v_fma_f32 v41, v49, v58, -v41
    v_fma_f32 v42, v50, v58, -v42
    v_fma_f32 v43, v51, v58, -v43
    v_fma_f32 v44, v52, v58, -v44
    v_fma_f32 v45, v53, v58, -v45
    v_fma_f32 v46, v54, v58, -v46
    v_fma_f32 v47, v55, v58, -v47
    v_cvt_pk_bf16_f32 v100, v48, v49
    v_cvt_pk_bf16_f32 v101, v50, v51
    v_cvt_pk_bf16_f32 v102, v52, v53
    v_cvt_pk_bf16_f32 v103, v54, v55
    v_fma_f32 v48, v40, v58, -v48
    v_fma_f32 v49, v41, v58, -v49
    v_fma_f32 v50, v42, v58, -v50
    v_fma_f32 v51, v43, v58, -v51
    v_fma_f32 v52, v44, v58, -v52
    v_fma_f32 v53, v45, v58, -v53
    v_fma_f32 v54, v46, v58, -v54
    v_fma_f32 v55, v47, v58, -v55
    s_waitcnt vmcnt(2)
    buffer_store_dword v87, v10, s[36:39], s48 offen sc1
    v_cvt_pk_bf16_f32 v104, v40, v41
    v_cvt_pk_bf16_f32 v105, v42, v43
    v_cvt_pk_bf16_f32 v106, v44, v45
    v_cvt_pk_bf16_f32 v107, v46, v47
    v_fma_f32 v40, v48, v58, -v40
    v_fma_f32 v41, v49, v58, -v41
    v_fma_f32 v42, v50, v58, -v42
    v_fma_f32 v43, v51, v58, -v43
    v_fma_f32 v44, v52, v58, -v44
    v_fma_f32 v45, v53, v58, -v45
    v_fma_f32 v46, v54, v58, -v46
    v_fma_f32 v47, v55, v58, -v47
    v_cvt_pk_bf16_f32 v108, v48, v49
    v_cvt_pk_bf16_f32 v109, v50, v51
    v_cvt_pk_bf16_f32 v110, v52, v53
    v_cvt_pk_bf16_f32 v111, v54, v55
    v_fma_f32 v48, v40, v58, -v48
    v_fma_f32 v49, v41, v58, -v49
    v_fma_f32 v50, v42, v58, -v50
    v_fma_f32 v51, v43, v58, -v51
    v_fma_f32 v52, v44, v58, -v52
    v_fma_f32 v53, v45, v58, -v53
    v_fma_f32 v54, v46, v58, -v54
    v_fma_f32 v55, v47, v58, -v55
    v_cvt_pk_bf16_f32 v112, v40, v41
    v_cvt_pk_bf16_f32 v113, v42, v43
    v_cvt_pk_bf16_f32 v114, v44, v45
    v_cvt_pk_bf16_f32 v115, v46, v47
    v_fma_f32 v40, v48, v58, -v40
    v_fma_f32 v41, v49, v58, -v41
    v_fma_f32 v42, v50, v58, -v42
    v_fma_f32 v43, v51, v58, -v43
    v_fma_f32 v44, v52, v58, -v44
    v_fma_f32 v45, v53, v58, -v45
    v_fma_f32 v46, v54, v58, -v46
    v_fma_f32 v47, v55, v58, -v47
    v_cvt_pk_bf16_f32 v116, v48, v49
    v_cvt_pk_bf16_f32 v117, v50, v51
    v_cvt_pk_bf16_f32 v118, v52, v53
    v_cvt_pk_bf16_f32 v119, v54, v55
    v_fma_f32 v48, v40, v58, -v48
    v_fma_f32 v49, v41, v58, -v49
    v_fma_f32 v50, v42, v58, -v50
    v_fma_f32 v51, v43, v58, -v51
    v_fma_f32 v52, v44, v58, -v52
    v_fma_f32 v53, v45, v58, -v53
    v_fma_f32 v54, v46, v58, -v54
    v_fma_f32 v55, v47, v58, -v55
    v_cvt_pk_bf16_f32 v120, v40, v41
    v_cvt_pk_bf16_f32 v121, v42, v43
    v_cvt_pk_bf16_f32 v122, v44, v45
    v_cvt_pk_bf16_f32 v123, v46, v47
    v_fma_f32 v40, v48, v58, -v40
    v_fma_f32 v41, v49, v58, -v41
    v_fma_f32 v42, v50, v58, -v42
    v_fma_f32 v43, v51, v58, -v43
    v_fma_f32 v44, v52, v58, -v44
    v_fma_f32 v45, v53, v58, -v45
    v_fma_f32 v46, v54, v58, -v46
    v_fma_f32 v47, v55, v58, -v47
    v_cvt_pk_bf16_f32 v124, v48, v49
    v_cvt_pk_bf16_f32 v125, v50, v51
    v_cvt_pk_bf16_f32 v126, v52, v53
    v_cvt_pk_bf16_f32 v127, v54, v55
    v_fma_f32 v48, v40, v58, -v48
    v_fma_f32 v49, v41, v58, -v49
    v_fma_f32 v50, v42, v58, -v50
    v_fma_f32 v51, v43, v58, -v51
    v_fma_f32 v52, v44, v58, -v52
    v_fma_f32 v53, v45, v58, -v53
    v_fma_f32 v54, v46, v58, -v54
    v_fma_f32 v55, v47, v58, -v55
    v_cvt_pk_bf16_f32 v128, v40, v41
    v_cvt_pk_bf16_f32 v129, v42, v43
    v_cvt_pk_bf16_f32 v130, v44, v45
    v_cvt_pk_bf16_f32 v131, v46, v47
    v_fma_f32 v40, v48, v58, -v40
    v_fma_f32 v41, v49, v58, -v41
    v_fma_f32 v42, v50, v58, -v42
    v_fma_f32 v43, v51, v58, -v43
    v_fma_f32 v44, v52, v58, -v44
    v_fma_f32 v45, v53, v58, -v45
    v_fma_f32 v46, v54, v58, -v46
    v_fma_f32 v47, v55, v58, -v47
    v_cvt_pk_bf16_f32 v132, v48, v49
    v_cvt_pk_bf16_f32 v133, v50, v51
    v_cvt_pk_bf16_f32 v134, v52, v53
    v_cvt_pk_bf16_f32 v135, v54, v55
    v_fma_f32 v48, v40, v58, -v48
    v_fma_f32 v49, v41, v58, -v49
    v_fma_f32 v50, v42, v58, -v50
    v_fma_f32 v51, v43, v58, -v51
    v_fma_f32 v52, v44, v58, -v52
    v_fma_f32 v53, v45, v58, -v53
    v_fma_f32 v54, v46, v58, -v54
    v_fma_f32 v55, v47, v58, -v55
    v_cvt_pk_bf16_f32 v136, v40, v41
    v_cvt_pk_bf16_f32 v137, v42, v43
    v_cvt_pk_bf16_f32 v138, v44, v45
    v_cvt_pk_bf16_f32 v139, v46, v47
    v_fma_f32 v40, v48, v58, -v40
    v_fma_f32 v41, v49, v58, -v41
    v_fma_f32 v42, v50, v58, -v42
    v_fma_f32 v43, v51, v58, -v43
    v_fma_f32 v44, v52, v58, -v44
    v_fma_f32 v45, v53, v58, -v45
    v_fma_f32 v46, v54, v58, -v46
    v_fma_f32 v47, v55, v58, -v47
    v_cvt_pk_bf16_f32 v140, v48, v49
    v_cvt_pk_bf16_f32 v141, v50, v51
    v_cvt_pk_bf16_f32 v142, v52, v53
    v_cvt_pk_bf16_f32 v143, v54, v55
    v_fma_f32 v48, v40, v58, -v48
    v_fma_f32 v49, v41, v58, -v49
    v_fma_f32 v50, v42, v58, -v50
    v_fma_f32 v51, v43, v58, -v51
    v_fma_f32 v52, v44, v58, -v52
    v_fma_f32 v53, v45, v58, -v53
    v_fma_f32 v54, v46, v58, -v54
    v_fma_f32 v55, v47, v58, -v55
    v_cvt_pk_bf16_f32 v144, v40, v41
    v_cvt_pk_bf16_f32 v145, v42, v43
    v_cvt_pk_bf16_f32 v146, v44, v45
    v_cvt_pk_bf16_f32 v147, v46, v47
    v_fma_f32 v40, v48, v58, -v40
    v_fma_f32 v41, v49, v58, -v41
    v_fma_f32 v42, v50, v58, -v42
    v_fma_f32 v43, v51, v58, -v43
    v_fma_f32 v44, v52, v58, -v44
    v_fma_f32 v45, v53, v58, -v45
    v_fma_f32 v46, v54, v58, -v46
    v_fma_f32 v47, v55, v58, -v47
    v_cvt_pk_bf16_f32 v148, v48, v49
    v_cvt_pk_bf16_f32 v149, v50, v51
    v_cvt_pk_bf16_f32 v150, v52, v53
    v_cvt_pk_bf16_f32 v151, v54, v55
    v_fma_f32 v48, v40, v58, -v48
    v_fma_f32 v49, v41, v58, -v49
    v_fma_f32 v50, v42, v58, -v50
    v_fma_f32 v51, v43, v58, -v51
    v_fma_f32 v52, v44, v58, -v52
    v_fma_f32 v53, v45, v58, -v53
    v_fma_f32 v54, v46, v58, -v54
    v_fma_f32 v55, v47, v58, -v55
    v_cvt_pk_bf16_f32 v152, v40, v41
    v_cvt_pk_bf16_f32 v153, v42, v43
    v_cvt_pk_bf16_f32 v154, v44, v45
    v_cvt_pk_bf16_f32 v155, v46, v47
    v_fma_f32 v40, v48, v58, -v40
    v_fma_f32 v41, v49, v58, -v41
    v_fma_f32 v42, v50, v58, -v42
    v_fma_f32 v43, v51, v58, -v43
    v_fma_f32 v44, v52, v58, -v44
    v_fma_f32 v45, v53, v58, -v45
    v_fma_f32 v46, v54, v58, -v46
    v_fma_f32 v47, v55, v58, -v47
    v_cvt_pk_bf16_f32 v156, v48, v49
    v_cvt_pk_bf16_f32 v157, v50, v51
    v_cvt_pk_bf16_f32 v158, v52, v53
    v_cvt_pk_bf16_f32 v159, v54, v55
    v_fma_f32 v48, v40, v58, -v48
    v_fma_f32 v49, v41, v58, -v49
    v_fma_f32 v50, v42, v58, -v50
    v_fma_f32 v51, v43, v58, -v51
    v_fma_f32 v52, v44, v58, -v52
    v_fma_f32 v53, v45, v58, -v53
    v_fma_f32 v54, v46, v58, -v54
    v_fma_f32 v55, v47, v58, -v55
    v_cvt_pk_bf16_f32 v160, v40, v41
    v_cvt_pk_bf16_f32 v161, v42, v43
    v_cvt_pk_bf16_f32 v162, v44, v45
    v_cvt_pk_bf16_f32 v163, v46, v47
    v_fma_f32 v40, v48, v58, -v40
    v_fma_f32 v41, v49, v58, -v41
    v_fma_f32 v42, v50, v58, -v42
    v_fma_f32 v43, v51, v58, -v43
    v_fma_f32 v44, v52, v58, -v44
    v_fma_f32 v45, v53, v58, -v45
    v_fma_f32 v46, v54, v58, -v46
    v_fma_f32 v47, v55, v58, -v47
    v_cvt_pk_bf16_f32 v164, v48, v49
    v_cvt_pk_bf16_f32 v165, v50, v51
    v_cvt_pk_bf16_f32 v166, v52, v53
    v_cvt_pk_bf16_f32 v167, v54, v55
    v_fma_f32 v48, v40, v58, -v48
    v_fma_f32 v49, v41, v58, -v49
    v_fma_f32 v50, v42, v58, -v50
    v_fma_f32 v51, v43, v58, -v51
    v_fma_f32 v52, v44, v58, -v52
    v_fma_f32 v53, v45, v58, -v53
    v_fma_f32 v54, v46, v58, -v54
    v_fma_f32 v55, v47, v58, -v55
    v_cvt_pk_bf16_f32 v168, v40, v41
    v_cvt_pk_bf16_f32 v169, v42, v43
    v_cvt_pk_bf16_f32 v170, v44, v45
    v_cvt_pk_bf16_f32 v171, v46, v47
    v_fma_f32 v40, v48, v58, -v40
    v_fma_f32 v41, v49, v58, -v41
    v_fma_f32 v42, v50, v58, -v42
    v_fma_f32 v43, v51, v58, -v43
    v_fma_f32 v44, v52, v58, -v44
    v_fma_f32 v45, v53, v58, -v45
    v_fma_f32 v46, v54, v58, -v46
    v_fma_f32 v47, v55, v58, -v47
    v_cvt_pk_bf16_f32 v172, v48, v49
    v_cvt_pk_bf16_f32 v173, v50, v51
    v_cvt_pk_bf16_f32 v174, v52, v53
    v_cvt_pk_bf16_f32 v175, v54, v55
    v_fma_f32 v48, v40, v58, -v48
    v_fma_f32 v49, v41, v58, -v49
    v_fma_f32 v50, v42, v58, -v50
    v_fma_f32 v51, v43, v58, -v51
    v_fma_f32 v52, v44, v58, -v52
    v_fma_f32 v53, v45, v58, -v53
    v_fma_f32 v54, v46, v58, -v54
    v_fma_f32 v55, v47, v58, -v55
    v_cvt_pk_bf16_f32 v176, v40, v41
    v_cvt_pk_bf16_f32 v177, v42, v43
    v_cvt_pk_bf16_f32 v178, v44, v45
    v_cvt_pk_bf16_f32 v179, v46, v47
    v_fma_f32 v40, v48, v58, -v40
    v_fma_f32 v41, v49, v58, -v41
    v_fma_f32 v42, v50, v58, -v42
    v_fma_f32 v43, v51, v58, -v43
    v_fma_f32 v44, v52, v58, -v44
    v_fma_f32 v45, v53, v58, -v45
    v_fma_f32 v46, v54, v58, -v46
    v_fma_f32 v47, v55, v58, -v47
    v_cvt_pk_bf16_f32 v180, v48, v49
    v_cvt_pk_bf16_f32 v181, v50, v51
    v_cvt_pk_bf16_f32 v182, v52, v53
    v_cvt_pk_bf16_f32 v183, v54, v55
    v_fma_f32 v48, v40, v58, -v48
    v_fma_f32 v49, v41, v58, -v49
    v_fma_f32 v50, v42, v58, -v50
    v_fma_f32 v51, v43, v58, -v51
    v_fma_f32 v52, v44, v58, -v52
    v_fma_f32 v53, v45, v58, -v53
    v_fma_f32 v54, v46, v58, -v54
    v_fma_f32 v55, v47, v58, -v55
    v_cvt_pk_bf16_f32 v184, v40, v41
    v_cvt_pk_bf16_f32 v185, v42, v43
    v_cvt_pk_bf16_f32 v186, v44, v45
    v_cvt_pk_bf16_f32 v187, v46, v47
    v_fma_f32 v40, v48, v58, -v40
    v_fma_f32 v41, v49, v58, -v41
    v_fma_f32 v42, v50, v58, -v42
    v_fma_f32 v43, v51, v58, -v43
    v_fma_f32 v44, v52, v58, -v44
    v_fma_f32 v45, v53, v58, -v45
    v_fma_f32 v46, v54, v58, -v46
    v_fma_f32 v47, v55, v58, -v47
    v_cvt_pk_bf16_f32 v188, v48, v49
    v_cvt_pk_bf16_f32 v189, v50, v51
    v_cvt_pk_bf16_f32 v190, v52, v53
    v_cvt_pk_bf16_f32 v191, v54, v55
    v_fma_f32 v48, v40, v58, -v48
    v_fma_f32 v49, v41, v58, -v49
    v_fma_f32 v50, v42, v58, -v50
    v_fma_f32 v51, v43, v58, -v51
    v_fma_f32 v52, v44, v58, -v52
    v_fma_f32 v53, v45, v58, -v53
    v_fma_f32 v54, v46, v58, -v54
    v_fma_f32 v55, v47, v58, -v55
    v_cvt_pk_bf16_f32 v192, v40, v41
    v_cvt_pk_bf16_f32 v193, v42, v43
    v_cvt_pk_bf16_f32 v194, v44, v45
    v_cvt_pk_bf16_f32 v195, v46, v47
    v_fma_f32 v40, v48, v58, -v40
    v_fma_f32 v41, v49, v58, -v41
    v_fma_f32 v42, v50, v58, -v42
    v_fma_f32 v43, v51, v58, -v43
    v_fma_f32 v44, v52, v58, -v44
    v_fma_f32 v45, v53, v58, -v45
    v_fma_f32 v46, v54, v58, -v46
    v_fma_f32 v47, v55, v58, -v47
    v_cvt_pk_bf16_f32 v196, v48, v49
    v_cvt_pk_bf16_f32 v197, v50, v51
    v_cvt_pk_bf16_f32 v198, v52, v53
    v_cvt_pk_bf16_f32 v199, v54, v55
    v_fma_f32 v48, v40, v58, -v48
    v_fma_f32 v49, v41, v58, -v49
    v_fma_f32 v50, v42, v58, -v50
    v_fma_f32 v51, v43, v58, -v51
    v_fma_f32 v52, v44, v58, -v52
    v_fma_f32 v53, v45, v58, -v53
    v_fma_f32 v54, v46, v58, -v54
    v_fma_f32 v55, v47, v58, -v55
    v_cvt_pk_bf16_f32 v200, v40, v41
    v_cvt_pk_bf16_f32 v201, v42, v43
    v_cvt_pk_bf16_f32 v202, v44, v45
    v_cvt_pk_bf16_f32 v203, v46, v47
    v_cvt_pk_bf16_f32 v204, v48, v49
    v_cvt_pk_bf16_f32 v205, v50, v51
    v_cvt_pk_bf16_f32 v206, v52, v53
    v_cvt_pk_bf16_f32 v207, v54, v55
    s_setprio 1
    v_lshlrev_b32 v39, 7, v4
    s_lshr_b32 s48, s42, 2
    s_lshl_b32 s48, s48, 2
    s_add_u32 s48, s48, s3
    s_lshl_b32 s48, s48, 13
    s_add_u32 s48, s48, 22609920
    buffer_load_dword v12, v39, s[36:39], s48 offen sc1
    s_mov_b32 s45, 65536
    s_waitcnt vmcnt(0)
POLL_23:
    v_xor_b32 v1, s44, v12
    v_cmp_ne_u32 vcc, 0, v1
    s_sub_u32 s45, s45, 1
    s_cbranch_scc1 PDONE_24
    s_cbranch_vccz PDONE_24
    s_mov_b64 exec, vcc
    buffer_load_dword v12, v39, s[36:39], s48 offen sc1
    s_waitcnt vmcnt(0)
    s_branch POLL_23
PDONE_24:
    s_mov_b64 exec, -1
    s_lshl_b32 s48, s42, 2
    s_add_u32 s48, s48, s40
    s_mul_i32 s48, s48, 32896
    s_lshl_b32 s49, s3, 13
    s_add_u32 s48, s48, s49
    s_add_u32 s48, s48, 4587520
    s_add_u32 s49, s48, 4096
    buffer_load_dwordx4 v[212:215], v9, s[36:39], s48 offen offset:0 sc1
    buffer_load_dwordx4 v[216:219], v9, s[36:39], s48 offen offset:1024 sc1
    buffer_load_dwordx4 v[220:223], v9, s[36:39], s48 offen offset:2048 sc1
    buffer_load_dwordx4 v[224:227], v9, s[36:39], s48 offen offset:3072 sc1
    buffer_load_dwordx4 v[228:231], v9, s[36:39], s49 offen offset:0 sc1
    buffer_load_dwordx4 v[232:235], v9, s[36:39], s49 offen offset:1024 sc1
    buffer_load_dwordx4 v[236:239], v9, s[36:39], s49 offen offset:2048 sc1
    buffer_load_dwordx4 v[240:243], v9, s[36:39], s49 offen offset:3072 sc1
    s_lshl_b32 s51, s42, 2
    s_add_u32 s51, s51, s41
    s_lshl_b32 s51, s51, 11
    s_lshl_b32 s49, s40, 9
    s_add_u32 s51, s51, s49
    s_add_u32 s51, s51, 22872064
    v_and_b32 v57, 3, v5
    v_lshlrev_b32 v57, 7, v57
    s_mov_b32 s45, 1048576
LW_25:
    ds_read_b128 v[208:211], v36 offset:48
    s_waitcnt lgkmcnt(0)
    v_min_u32 v208, v208, v209
    v_min3_u32 v208, v208, v210, v211
    v_cmp_eq_u32 vcc, 0, v208
    s_sub_u32 s45, s45, 1
    s_cbranch_scc1 LD_26
    s_cbranch_vccnz LW_25
LD_26:
    v_bfe_u32 v1, v4, 2, 2
    v_lshl_add_u32 v1, v6, 2, v1
    v_lshlrev_b32 v1, 7, v1
    v_and_b32 v2, 16, v4
    v_lshl_add_u32 v1, v2, 2, v1
    v_and_b32 v2, 3, v4
    v_lshl_add_u32 v1, v2, 4, v1
    v_and_b32 v2, 8, v4
    v_add_u32 v1, v1, v2
    v_add_u32 v39, 98304, v1
    v_xor_b32 v56, 8, v39
    s_waitcnt vmcnt(7)
    ds_write_b128 v32, v[212:215] offset:0
    s_waitcnt vmcnt(6)
    ds_write_b128 v32, v[216:219] offset:1024
    s_waitcnt vmcnt(5)
    ds_write_b128 v32, v[220:223] offset:2048
    s_waitcnt vmcnt(4)
    ds_write_b128 v32, v[224:227] offset:3072
    s_waitcnt vmcnt(3)
    ds_write_b128 v32, v[228:231] offset:4096
    s_waitcnt vmcnt(2)
    ds_write_b128 v32, v[232:235] offset:5120
    s_waitcnt vmcnt(1)
    ds_write_b128 v32, v[236:239] offset:6144
    s_waitcnt vmcnt(0)
    ds_write_b128 v32, v[240:243] offset:7168
    ds_write_b32 v38, v38 offset:64
    s_waitcnt lgkmcnt(0)
    s_lshl_b32 s48, s3, 11
    s_add_u32 s48, s48, 139264
    v_add_u32 v242, s48, v9
    v_bfe_u32 v1, v5, 1, 2
    v_xor_b32 v1, v1, v6
    v_lshlrev_b32 v1, 4, v1
    v_lshl_add_u32 v1, v5, 6, v1
    v_add_u32 v240, s48, v1
    v_bfe_u32 v1, v4, 3, 2
    v_lshlrev_b32 v1, 4, v1
    v_xor_b32 v241, v1, v242
    v_mov_b32 v14, 0xbfb8aa3b
    s_mov_b32 s45, 1048576
LW_27:
    ds_read_b128 v[208:211], v36 offset:64
    s_waitcnt lgkmcnt(0)
    v_min_u32 v208, v208, v209
    v_min3_u32 v208, v208, v210, v211
    v_cmp_eq_u32 vcc, 0, v208
    s_sub_u32 s45, s45, 1
    s_cbranch_scc1 LD_28
    s_cbranch_vccnz LW_27
LD_28:
    s_or_b32 s48, s2, s3
    s_cmp_lg_u32 s48, 0
    s_cbranch_scc1 NON_29
    s_mov_b32 s48, 0
    buffer_store_dword v87, v10, s[36:39], s48 offen sc1
NON_29:
    ds_read_b64_tr_b16 v[212:213], v39 offset:0
    ds_read_b64_tr_b16 v[214:215], v56 offset:0
    ds_read_b64_tr_b16 v[216:217], v39 offset:1024
    ds_read_b64_tr_b16 v[218:219], v56 offset:1024
    ds_read_b64_tr_b16 v[220:221], v39 offset:2048
    ds_read_b64_tr_b16 v[222:223], v56 offset:2048
    ds_read_b64_tr_b16 v[224:225], v39 offset:3072
    ds_read_b64_tr_b16 v[226:227], v56 offset:3072
    s_waitcnt lgkmcnt(6)
    v_mfma_f32_32x32x16_bf16 v[60:75], v[24:27], v[212:215], 0
    ds_read_b64_tr_b16 v[228:229], v39 offset:4096
    ds_read_b64_tr_b16 v[230:231], v56 offset:4096
    s_waitcnt lgkmcnt(6)
    v_mfma_f32_32x32x16_bf16 v[60:75], v[28:31], v[216:219], v[60:75]
    ds_read_b64_tr_b16 v[212:213], v39 offset:5120
    ds_read_b64_tr_b16 v[214:215], v56 offset:5120
    s_waitcnt lgkmcnt(6)
    v_mfma_f32_32x32x16_bf16 v[60:75], v[88:91], v[220:223], v[60:75]
    ds_read_b64_tr_b16 v[216:217], v39 offset:6144
    ds_read_b64_tr_b16 v[218:219], v56 offset:6144
    buffer_load_dword v12, v57, s[36:39], s51 offen sc1
    s_waitcnt lgkmcnt(6)
    v_mfma_f32_32x32x16_bf16 v[60:75], v[92:95], v[224:227], v[60:75]
    ds_read_b64_tr_b16 v[220:221], v39 offset:7168
    ds_read_b64_tr_b16 v[222:223], v56 offset:7168
    s_waitcnt lgkmcnt(6)
    v_mfma_f32_32x32x16_bf16 v[60:75], v[96:99], v[228:231], v[60:75]
    ds_read_b64_tr_b16 v[224:225], v39 offset:8192
    ds_read_b64_tr_b16 v[226:227], v56 offset:8192
    s_waitcnt lgkmcnt(6)
    v_mfma_f32_32x32x16_bf16 v[60:75], v[100:103], v[212:215], v[60:75]
    ds_read_b64_tr_b16 v[228:229], v39 offset:9216
    ds_read_b64_tr_b16 v[230:231], v56 offset:9216
    v_lshlrev_b32 v24, 16, v78
    v_and_b32 v25, 0xffff0000, v78
    v_lshlrev_b32 v26, 16, v79
    v_and_b32 v27, 0xffff0000, v79
    v_lshlrev_b32 v28, 16, v80
    v_and_b32 v29, 0xffff0000, v80
    s_waitcnt lgkmcnt(6)
    v_mfma_f32_32x32x16_bf16 v[60:75], v[104:107], v[216:219], v[60:75]
    ds_read_b64_tr_b16 v[212:213], v39 offset:10240
    ds_read_b64_tr_b16 v[214:215], v56 offset:10240
    v_lshlrev_b32 v30, 16, v81
    v_and_b32 v31, 0xffff0000, v81
    v_lshlrev_b32 v88, 16, v82
    v_and_b32 v89, 0xffff0000, v82
    v_lshlrev_b32 v90, 16, v83
    v_and_b32 v91, 0xffff0000, v83
    s_waitcnt lgkmcnt(6)
    v_mfma_f32_32x32x16_bf16 v[60:75], v[108:111], v[220:223], v[60:75]
    ds_read_b64_tr_b16 v[216:217], v39 offset:11264
    ds_read_b64_tr_b16 v[218:219], v56 offset:11264
    v_lshlrev_b32 v92, 16, v84
    v_and_b32 v93, 0xffff0000, v84
    v_lshlrev_b32 v94, 16, v85
    v_and_b32 v95, 0xffff0000, v85
    s_waitcnt lgkmcnt(6)
    v_mfma_f32_32x32x16_bf16 v[60:75], v[112:115], v[224:227], v[60:75]
    ds_read_b64_tr_b16 v[220:221], v39 offset:12288
    ds_read_b64_tr_b16 v[222:223], v56 offset:12288
    s_waitcnt lgkmcnt(6)
    v_mfma_f32_32x32x16_bf16 v[60:75], v[116:119], v[228:231], v[60:75]
    ds_read_b64_tr_b16 v[224:225], v39 offset:13312
    ds_read_b64_tr_b16 v[226:227], v56 offset:13312
    s_waitcnt lgkmcnt(6)
    v_mfma_f32_32x32x16_bf16 v[60:75], v[120:123], v[212:215], v[60:75]
    ds_read_b64_tr_b16 v[228:229], v39 offset:14336
    ds_read_b64_tr_b16 v[230:231], v56 offset:14336
    s_waitcnt lgkmcnt(6)
    v_mfma_f32_32x32x16_bf16 v[60:75], v[124:127], v[216:219], v[60:75]
    ds_read_b64_tr_b16 v[212:213], v39 offset:15360
    ds_read_b64_tr_b16 v[214:215], v56 offset:15360
    s_waitcnt lgkmcnt(6)
    v_mfma_f32_32x32x16_bf16 v[60:75], v[128:131], v[220:223], v[60:75]
    ds_read_b64_tr_b16 v[216:217], v39 offset:16384
    ds_read_b64_tr_b16 v[218:219], v56 offset:16384
    s_waitcnt lgkmcnt(6)
    v_mfma_f32_32x32x16_bf16 v[60:75], v[132:135], v[224:227], v[60:75]
    ds_read_b64_tr_b16 v[220:221], v39 offset:17408
    ds_read_b64_tr_b16 v[222:223], v56 offset:17408
    s_waitcnt lgkmcnt(6)
    v_mfma_f32_32x32x16_bf16 v[60:75], v[136:139], v[228:231], v[60:75]
    ds_read_b64_tr_b16 v[224:225], v39 offset:18432
    ds_read_b64_tr_b16 v[226:227], v56 offset:18432
    s_waitcnt vmcnt(11)
    v_lshlrev_b32 v112, 16, v16
    v_and_b32 v113, 0xffff0000, v16
    v_lshlrev_b32 v114, 16, v17
    v_and_b32 v115, 0xffff0000, v17
    v_lshlrev_b32 v116, 16, v18
    v_and_b32 v117, 0xffff0000, v18
    s_waitcnt lgkmcnt(6)
    v_mfma_f32_32x32x16_bf16 v[60:75], v[140:143], v[212:215], v[60:75]
    ds_read_b64_tr_b16 v[228:229], v39 offset:19456
    ds_read_b64_tr_b16 v[230:231], v56 offset:19456
    v_lshlrev_b32 v118, 16, v19
    v_and_b32 v119, 0xffff0000, v19
    v_lshlrev_b32 v120, 16, v20
    v_and_b32 v121, 0xffff0000, v20
    v_lshlrev_b32 v122, 16, v21
    v_and_b32 v123, 0xffff0000, v21
    s_waitcnt lgkmcnt(6)
    v_mfma_f32_32x32x16_bf16 v[60:75], v[144:147], v[216:219], v[60:75]
    ds_read_b64_tr_b16 v[212:213], v39 offset:20480
    ds_read_b64_tr_b16 v[214:215], v56 offset:20480
    v_lshlrev_b32 v124, 16, v22
    v_and_b32 v125, 0xffff0000, v22
    v_lshlrev_b32 v126, 16, v23
    v_and_b32 v127, 0xffff0000, v23
    s_waitcnt lgkmcnt(6)
    v_mfma_f32_32x32x16_bf16 v[60:75], v[148:151], v[220:223], v[60:75]
    ds_read_b64_tr_b16 v[216:217], v39 offset:21504
    ds_read_b64_tr_b16 v[218:219], v56 offset:21504
    s_waitcnt lgkmcnt(6)
    v_mfma_f32_32x32x16_bf16 v[60:75], v[152:155], v[224:227], v[60:75]
    ds_read_b64_tr_b16 v[220:221], v39 offset:22528
    ds_read_b64_tr_b16 v[222:223], v56 offset:22528
    s_waitcnt lgkmcnt(6)
    v_mfma_f32_32x32x16_bf16 v[60:75], v[156:159], v[228:231], v[60:75]
    ds_read_b64_tr_b16 v[224:225], v39 offset:23552
    ds_read_b64_tr_b16 v[226:227], v56 offset:23552
    s_waitcnt lgkmcnt(6)
    v_mfma_f32_32x32x16_bf16 v[60:75], v[160:163], v[212:215], v[60:75]
    ds_read_b64_tr_b16 v[228:229], v39 offset:24576
    ds_read_b64_tr_b16 v[230:231], v56 offset:24576
    s_waitcnt lgkmcnt(6)
    v_mfma_f32_32x32x16_bf16 v[60:75], v[164:167], v[216:219], v[60:75]
    ds_read_b64_tr_b16 v[212:213], v39 offset:25600
    ds_read_b64_tr_b16 v[214:215], v56 offset:25600
    s_mov_b32 s45, 65536
    s_waitcnt vmcnt(0)
POLL_30:
    v_xor_b32 v1, s44, v12
    v_cmp_ne_u32 vcc, 0, v1
    s_sub_u32 s45, s45, 1
    s_cbranch_scc1 PDONE_31
    s_cbranch_vccz PDONE_31
    s_mov_b64 exec, vcc
    buffer_load_dword v12, v57, s[36:39], s51 offen sc1
    s_waitcnt vmcnt(0)
    s_branch POLL_30
PDONE_31:
    s_mov_b64 exec, -1
    s_lshl_b32 s48, s42, 6
    s_lshl_b32 s49, s41, 2
    s_add_u32 s48, s48, s49
    s_add_u32 s48, s48, s40
    s_lshl_b32 s48, s48, 13
    s_lshl_b32 s49, s3, 11
    s_add_u32 s48, s48, s49
    s_add_u32 s48, s48, 14090240
    s_add_u32 s49, s40, 1
    s_and_b32 s49, s49, 3
    s_lshl_b32 s49, s49, 17
    s_add_u32 s49, s49, s48
    buffer_load_dwordx4 v[40:43], v9, s[36:39], s49 offen offset:0 sc1
    buffer_load_dwordx4 v[44:47], v9, s[36:39], s49 offen offset:1024 sc1
    s_add_u32 s49, s40, 2
    s_and_b32 s49, s49, 3
    s_lshl_b32 s49, s49, 17
    s_add_u32 s49, s49, s48
    buffer_load_dwordx4 v[48:51], v9, s[36:39], s49 offen offset:0 sc1
    buffer_load_dwordx4 v[52:55], v9, s[36:39], s49 offen offset:1024 sc1
    s_add_u32 s49, s40, 3
    s_and_b32 s49, s49, 3
    s_lshl_b32 s49, s49, 17
    s_add_u32 s49, s49, s48
    buffer_load_dwordx4 v[232:235], v9, s[36:39], s49 offen offset:0 sc1
    buffer_load_dwordx4 v[236:239], v9, s[36:39], s49 offen offset:1024 sc1
    ds_read_b128 v[96:99], v242
    ds_read_b128 v[100:103], v242 offset:1024
    s_mov_b32 s50, 0x00003f80
    s_mov_b32 s51, 0x3f800000
    s_waitcnt lgkmcnt(8)
    v_mfma_f32_32x32x16_bf16 v[60:75], v[168:171], v[220:223], v[60:75]
    ds_read_b64_tr_b16 v[216:217], v39 offset:26624
    ds_read_b64_tr_b16 v[218:219], v56 offset:26624
    s_waitcnt lgkmcnt(8)
    v_mfma_f32_32x32x16_bf16 v[60:75], v[172:175], v[224:227], v[60:75]
    ds_read_b64_tr_b16 v[220:221], v39 offset:27648
    ds_read_b64_tr_b16 v[222:223], v56 offset:27648
    s_waitcnt lgkmcnt(8)
    v_mfma_f32_32x32x16_bf16 v[60:75], v[176:179], v[228:231], v[60:75]
    ds_read_b64_tr_b16 v[224:225], v39 offset:28672
    ds_read_b64_tr_b16 v[226:227], v56 offset:28672
    s_waitcnt lgkmcnt(8)
    v_mfma_f32_32x32x16_bf16 v[60:75], v[180:183], v[212:215], v[60:75]
    ds_read_b64_tr_b16 v[228:229], v39 offset:29696
    ds_read_b64_tr_b16 v[230:231], v56 offset:29696
    s_waitcnt lgkmcnt(6)
    v_mfma_f32_32x32x16_bf16 v[60:75], v[184:187], v[216:219], v[60:75]
    ds_read_b64_tr_b16 v[212:213], v39 offset:30720
    ds_read_b64_tr_b16 v[214:215], v56 offset:30720
    s_waitcnt lgkmcnt(6)
    v_mfma_f32_32x32x16_bf16 v[60:75], v[188:191], v[220:223], v[60:75]
    ds_read_b64_tr_b16 v[216:217], v39 offset:31744
    ds_read_b64_tr_b16 v[218:219], v56 offset:31744
    s_waitcnt lgkmcnt(6)
    v_mfma_f32_32x32x16_bf16 v[60:75], v[192:195], v[224:227], v[60:75]
    s_waitcnt lgkmcnt(4)
    v_mfma_f32_32x32x16_bf16 v[60:75], v[196:199], v[228:231], v[60:75]
    s_waitcnt lgkmcnt(2)
    v_mfma_f32_32x32x16_bf16 v[60:75], v[200:203], v[212:215], v[60:75]
    s_waitcnt lgkmcnt(0)
    v_mfma_f32_32x32x16_bf16 v[60:75], v[204:207], v[216:219], v[60:75]
    s_waitcnt lgkmcnt(12)
    v_dot2c_f32_bf16 v24, s50, v96
    v_dot2c_f32_bf16 v25, s51, v96
    v_dot2c_f32_bf16 v26, s50, v97
    v_dot2c_f32_bf16 v27, s51, v97
    v_dot2c_f32_bf16 v28, s50, v98
    v_dot2c_f32_bf16 v29, s51, v98
    v_dot2c_f32_bf16 v30, s50, v99
    v_dot2c_f32_bf16 v31, s51, v99
    v_dot2c_f32_bf16 v88, s50, v100
    v_dot2c_f32_bf16 v89, s51, v100
    v_dot2c_f32_bf16 v90, s50, v101
    v_dot2c_f32_bf16 v91, s51, v101
    v_dot2c_f32_bf16 v92, s50, v102
    v_dot2c_f32_bf16 v93, s51, v102
    v_dot2c_f32_bf16 v94, s50, v103
    v_dot2c_f32_bf16 v95, s51, v103
    s_waitcnt vmcnt(4)
    v_dot2c_f32_bf16 v24, s50, v40
    v_dot2c_f32_bf16 v25, s51, v40
    v_dot2c_f32_bf16 v26, s50, v41
    v_dot2c_f32_bf16 v27, s51, v41
    v_dot2c_f32_bf16 v28, s50, v42
    v_dot2c_f32_bf16 v29, s51, v42
    v_dot2c_f32_bf16 v30, s50, v43
    v_dot2c_f32_bf16 v31, s51, v43
    v_dot2c_f32_bf16 v88, s50, v44
    v_dot2c_f32_bf16 v89, s51, v44
    v_dot2c_f32_bf16 v90, s50, v45
    v_dot2c_f32_bf16 v91, s51, v45
    v_dot2c_f32_bf16 v92, s50, v46
    v_dot2c_f32_bf16 v93, s51, v46
    v_dot2c_f32_bf16 v94, s50, v47
    v_dot2c_f32_bf16 v95, s51, v47
    s_waitcnt vmcnt(2)
    v_dot2c_f32_bf16 v24, s50, v48
    v_dot2c_f32_bf16 v25, s51, v48
    v_dot2c_f32_bf16 v26, s50, v49
    v_dot2c_f32_bf16 v27, s51, v49
    v_dot2c_f32_bf16 v28, s50, v50
    v_dot2c_f32_bf16 v29, s51, v50
    v_dot2c_f32_bf16 v30, s50, v51
    v_dot2c_f32_bf16 v31, s51, v51
    v_dot2c_f32_bf16 v88, s50, v52
    v_dot2c_f32_bf16 v89, s51, v52
    v_dot2c_f32_bf16 v90, s50, v53
    v_dot2c_f32_bf16 v91, s51, v53
    v_dot2c_f32_bf16 v92, s50, v54
    v_dot2c_f32_bf16 v93, s51, v54
    v_dot2c_f32_bf16 v94, s50, v55
    v_dot2c_f32_bf16 v95, s51, v55
    s_waitcnt vmcnt(0)
    v_dot2c_f32_bf16 v24, s50, v232
    v_dot2c_f32_bf16 v25, s51, v232
    v_dot2c_f32_bf16 v26, s50, v233
    v_dot2c_f32_bf16 v27, s51, v233
    v_dot2c_f32_bf16 v28, s50, v234
    v_dot2c_f32_bf16 v29, s51, v234
    v_dot2c_f32_bf16 v30, s50, v235
    v_dot2c_f32_bf16 v31, s51, v235
    v_dot2c_f32_bf16 v88, s50, v236
    v_dot2c_f32_bf16 v89, s51, v236
    v_dot2c_f32_bf16 v90, s50, v237
    v_dot2c_f32_bf16 v91, s51, v237
    v_dot2c_f32_bf16 v92, s50, v238
    v_dot2c_f32_bf16 v93, s51, v238
    v_dot2c_f32_bf16 v94, s50, v239
    v_dot2c_f32_bf16 v95, s51, v239
    v_pk_mul_f32 v[104:105], v[24:25], v[14:15] op_sel_hi:[1,0]
    v_pk_mul_f32 v[106:107], v[26:27], v[14:15] op_sel_hi:[1,0]
    v_pk_mul_f32 v[108:109], v[28:29], v[14:15] op_sel_hi:[1,0]
    v_pk_mul_f32 v[110:111], v[30:31], v[14:15] op_sel_hi:[1,0]
    v_pk_mul_f32 v[128:129], v[88:89], v[14:15] op_sel_hi:[1,0]
    v_pk_mul_f32 v[130:131], v[90:91], v[14:15] op_sel_hi:[1,0]
    v_pk_mul_f32 v[132:133], v[92:93], v[14:15] op_sel_hi:[1,0]
    v_pk_mul_f32 v[134:135], v[94:95], v[14:15] op_sel_hi:[1,0]
    v_exp_f32 v104, v104
    v_exp_f32 v105, v105
    v_exp_f32 v106, v106
    v_exp_f32 v107, v107
    v_exp_f32 v108, v108
    v_exp_f32 v109, v109
    v_exp_f32 v110, v110
    v_exp_f32 v111, v111
    v_exp_f32 v128, v128
    v_exp_f32 v129, v129
    v_exp_f32 v130, v130
    v_exp_f32 v131, v131
    v_exp_f32 v132, v132
    v_exp_f32 v133, v133
    v_exp_f32 v134, v134
    v_exp_f32 v135, v135
    v_pk_add_f32 v[104:105], v[104:105], 1.0 op_sel_hi:[1,0]
    v_pk_add_f32 v[106:107], v[106:107], 1.0 op_sel_hi:[1,0]
    v_pk_add_f32 v[108:109], v[108:109], 1.0 op_sel_hi:[1,0]
    v_pk_add_f32 v[110:111], v[110:111], 1.0 op_sel_hi:[1,0]
    v_pk_add_f32 v[128:129], v[128:129], 1.0 op_sel_hi:[1,0]
    v_pk_add_f32 v[130:131], v[130:131], 1.0 op_sel_hi:[1,0]
    v_pk_add_f32 v[132:133], v[132:133], 1.0 op_sel_hi:[1,0]
    v_pk_add_f32 v[134:135], v[134:135], 1.0 op_sel_hi:[1,0]
    v_rcp_f32 v104, v104
    v_rcp_f32 v105, v105
    v_rcp_f32 v106, v106
    v_rcp_f32 v107, v107
    v_rcp_f32 v108, v108
    v_rcp_f32 v109, v109
    v_rcp_f32 v110, v110
    v_rcp_f32 v111, v111
    v_rcp_f32 v128, v128
    v_rcp_f32 v129, v129
    v_rcp_f32 v130, v130
    v_rcp_f32 v131, v131
    v_rcp_f32 v132, v132
    v_rcp_f32 v133, v133
    v_rcp_f32 v134, v134
    v_rcp_f32 v135, v135
    v_pk_mul_f32 v[24:25], v[24:25], v[60:61]
    v_pk_mul_f32 v[26:27], v[26:27], v[62:63]
    v_pk_mul_f32 v[28:29], v[28:29], v[64:65]
    v_pk_mul_f32 v[30:31], v[30:31], v[66:67]
    v_pk_mul_f32 v[104:105], v[104:105], v[24:25]
    v_pk_mul_f32 v[106:107], v[106:107], v[26:27]
    v_pk_mul_f32 v[108:109], v[108:109], v[28:29]
    v_pk_mul_f32 v[110:111], v[110:111], v[30:31]
    v_cvt_pk_bf16_f32 v136, v104, v105
    v_cvt_pk_bf16_f32 v137, v106, v107
    v_cvt_pk_bf16_f32 v138, v108, v109
    v_cvt_pk_bf16_f32 v139, v110, v111
    ds_write_b128 v240, v[136:139]
    v_pk_mul_f32 v[88:89], v[88:89], v[68:69]
    v_pk_mul_f32 v[90:91], v[90:91], v[70:71]
    v_pk_mul_f32 v[92:93], v[92:93], v[72:73]
    v_pk_mul_f32 v[94:95], v[94:95], v[74:75]
    v_pk_mul_f32 v[128:129], v[128:129], v[88:89]
    v_pk_mul_f32 v[130:131], v[130:131], v[90:91]
    v_pk_mul_f32 v[132:133], v[132:133], v[92:93]
    v_pk_mul_f32 v[134:135], v[134:135], v[94:95]
    v_cvt_pk_bf16_f32 v140, v128, v129
    v_cvt_pk_bf16_f32 v141, v130, v131
    v_cvt_pk_bf16_f32 v142, v132, v133
    v_cvt_pk_bf16_f32 v143, v134, v135
    v_xor_b32 v240, 32, v240
    ds_write_b128 v240, v[140:143]
    ds_read_b128 v[78:81], v241 offset:0
    ds_read_b128 v[82:85], v241 offset:1024
    s_waitcnt lgkmcnt(1)
    v_dot2c_f32_bf16 v112, s50, v78
    v_dot2c_f32_bf16 v113, s51, v78
    v_dot2c_f32_bf16 v114, s50, v79
    v_dot2c_f32_bf16 v115, s51, v79
    v_dot2c_f32_bf16 v116, s50, v80
    v_dot2c_f32_bf16 v117, s51, v80
    v_dot2c_f32_bf16 v118, s50, v81
    v_dot2c_f32_bf16 v119, s51, v81
    v_cvt_pk_bf16_f32 v16, v112, v113
    v_cvt_pk_bf16_f32 v17, v114, v115
    v_cvt_pk_bf16_f32 v18, v116, v117
    v_cvt_pk_bf16_f32 v19, v118, v119
    buffer_store_dwordx4 v[16:19], v11, s[32:35], s61 offen
    s_waitcnt lgkmcnt(0)
    v_dot2c_f32_bf16 v120, s50, v82
    v_dot2c_f32_bf16 v121, s51, v82
    v_dot2c_f32_bf16 v122, s50, v83
    v_dot2c_f32_bf16 v123, s51, v83
    v_dot2c_f32_bf16 v124, s50, v84
    v_dot2c_f32_bf16 v125, s51, v84
    v_dot2c_f32_bf16 v126, s50, v85
    v_dot2c_f32_bf16 v127, s51, v85
    v_cvt_pk_bf16_f32 v20, v120, v121
    v_cvt_pk_bf16_f32 v21, v122, v123
    v_cvt_pk_bf16_f32 v22, v124, v125
    v_cvt_pk_bf16_f32 v23, v126, v127
    buffer_store_dwordx4 v[20:23], v11, s[32:35], s62 offen
    s_endpgm
END:
    s_endpgm
CODE_END:
.section .rodata,"a"
.p2align 6
.amdhsa_kernel recurrent_scan__spectral_gfnet__mixer_channel_mlp__prompt_kernel
  .amdhsa_next_free_vgpr 256
  .amdhsa_next_free_sgpr 102
  .amdhsa_accum_offset 256
  .amdhsa_group_segment_fixed_size 0
  .amdhsa_kernarg_size 88
  .amdhsa_user_sgpr_count 2
  .amdhsa_user_sgpr_kernarg_segment_ptr 1
  .amdhsa_system_sgpr_workgroup_id_x 1
.end_amdhsa_kernel
```
